```python
import torch

def _softmax(x, axis=-1):
    return torch.softmax(x, dim=axis)
def _gelu(x):
    return torch.nn.functional.gelu(x, approximate="tanh")
def _silu(x):
    return torch.nn.functional.silu(x)
def _sigmoid(x):
    return torch.sigmoid(x)
def _layernorm(x, axis=-1, eps=1e-5):
    m = x.mean(dim=axis, keepdim=True)
    v = x.var(dim=axis, keepdim=True, unbiased=False)
    return (x - m) / torch.sqrt(v + eps)
def _scatter_add(tgt, idx, src, axis=0):
    return tgt.clone().index_add_(axis, idx, src)
def _segment_sum(src, seg, n):
    out = torch.zeros((n,) + src.shape[1:], dtype=src.dtype)
    return out.index_add_(0, seg, src)
def _pad(x, pw):
    flat = tuple(v for pair in reversed(pw) for v in pair)
    return torch.nn.functional.pad(x, flat)

kernel_name = 'standalone__molecular_angular_gemnet__graph'

def setup_inputs():

    _w = (lambda a: (lambda t: t.to(torch.bfloat16) if t.is_floating_point() else t)(torch.as_tensor(a)))
    N, deg, De, L = 10000, 32, 16, 1
    E = N * deg
    T = E * deg
    NR = 8
    dist = torch.rand(E).to(float)
    angle = (torch.rand(T) * torch.pi).to(float)
    centers = torch.linspace(0.0, 1.0, NR).to(float)
    ang_freq = torch.arange(1, L + 1).to(float)
    return {
        "m": _w((lambda *s: torch.randn(*s, dtype=torch.bfloat16) * 0.05)(E, De)),
        "idx_in": _w((lambda lo, hi, *s: torch.randint(lo, hi, s))(0, E, T).to(torch.int64)),
        "idx_out": _w((lambda lo, hi, *s: torch.randint(lo, hi, s))(0, E, T).to(torch.int64)),
        "dist": _w(dist),
        "angle": _w(angle),
        "centers": _w(centers),
        "ang_freq": _w(ang_freq),
        "w_rbf": _w((lambda *s: torch.randn(*s, dtype=torch.bfloat16) * 0.2)(NR, De)),
        "w_sbf": _w((lambda *s: torch.randn(*s, dtype=torch.bfloat16) * 0.2)(NR * L, De)),
        "w_down": _w((lambda *s: torch.randn(*s, dtype=torch.bfloat16) * 0.2)(De, De)),
        "w_up": _w((lambda *s: torch.randn(*s, dtype=torch.bfloat16) * 0.2)(De, De)),
    }

def reference(m, idx_in, idx_out, dist, angle, centers, ang_freq, w_rbf, w_sbf, w_down, w_up):
    E, De = m.shape[0], m.shape[1]
    NR = centers.shape[0]
    L = ang_freq.shape[0]
    rbf = torch.exp(-10.0 * (dist[:, None] - centers[None, :]) ** 2)
    cbf = torch.cos(ang_freq[None, :] * angle[:, None])
    rbf_t = rbf[idx_out]
    sbf = torch.reshape(rbf_t[:, :, None] * cbf[:, None, :], (-1, NR * L))
    x = (m[idx_in] @ w_down) * (sbf @ w_sbf)
    agg = _segment_sum(x, idx_out, E)
    return m + (agg @ w_up) * (rbf @ w_rbf)
```

```asm
; @launch kernel=k1_kernel grid=(256,1,1) block=(1024,1,1) lds=133248
; @launch kernel=k2_kernel grid=(256,1,1) block=(1024,1,1) lds=163840
.amdgcn_target "amdgcn-amd-amdhsa--gfx950"
.text
.p2align 8
.globl k1_kernel
.type k1_kernel,@function
k1_kernel:
  s_cmp_ge_u32 s2, 256
  s_cbranch_scc1 L_k1_end
  s_load_dwordx4 s[4:7], s[0:1], 8
  s_load_dwordx2 s[44:45], s[0:1], 32
  s_load_dwordx2 s[46:47], s[0:1], 48
  s_load_dwordx2 s[48:49], s[0:1], 104
  s_and_b32 s3, s2, 7
  s_lshl_b32 s3, s3, 5
  s_lshr_b32 s36, s2, 3
  s_add_u32 s3, s3, s36
  s_add_u32 s36, s3, 256
  v_lshlrev_b32 v1, 4, v0
  v_lshlrev_b32 v2, 3, v0
  v_mov_b32 v3, 1
  v_lshlrev_b32 v16, 2, v0
  v_and_b32 v17, 15, v0
  v_lshlrev_b32 v17, 2, v17
  v_lshlrev_b32 v18, 11, v0
  v_add_u32 v19, 49152, v1
  v_lshrrev_b32 v4, 6, v0
  s_nop 0
  v_readfirstlane_b32 s35, v4
  s_mov_b32 s28, 3435974
  s_mov_b32 s29, -1250
  s_mov_b32 s30, 53248
  s_mov_b32 s32, 0x80000000
  s_mov_b32 s33, 0x3e22f900
  s_mov_b32 s34, 0x36036e4e
  s_mov_b32 s37, 0x7f000000
  s_mov_b32 s38, 0xffff0000
  s_mov_b32 s39, 0xfff
  v_mov_b32 v9, 0
  ds_write_b32 v16, v9 offset:0
  s_waitcnt lgkmcnt(0)
  s_mov_b32 s12, s4
  s_mov_b32 s13, s5
  s_mov_b32 s14, 40960000
  s_mov_b32 s15, 0x20000
  s_mov_b32 s8, s6
  s_mov_b32 s9, s7
  s_mov_b32 s10, 40960000
  s_mov_b32 s11, 0x20000
  s_mov_b32 s16, s44
  s_mov_b32 s17, s45
  s_mov_b32 s18, 20480000
  s_mov_b32 s19, 0x20000
  s_mov_b32 s20, s48
  s_mov_b32 s21, s49
  s_mov_b32 s22, 64512000
  s_mov_b32 s23, 0x20000
  s_add_u32 s24, s48, 64512000
  s_addc_u32 s25, s49, 0
  s_mov_b32 s26, 2097152
  s_mov_b32 s27, 0x20000
  s_load_dword s31, s[46:47], 0
  s_mul_i32 s40, s3, 81920
  s_mul_i32 s42, s3, 40960
  buffer_load_dwordx4 v[20:23], v1, s[8:11], s40 offen nt
  buffer_load_dwordx4 v[40:43], v1, s[12:15], s40 offen nt
  buffer_load_dwordx2 v[60:61], v2, s[16:19], s42 offen nt
  s_add_u32 s40, s40, 16384
  s_add_u32 s42, s42, 8192
  buffer_load_dwordx4 v[24:27], v1, s[8:11], s40 offen nt
  buffer_load_dwordx4 v[44:47], v1, s[12:15], s40 offen nt
  buffer_load_dwordx2 v[62:63], v2, s[16:19], s42 offen nt
  s_add_u32 s40, s40, 16384
  s_add_u32 s42, s42, 8192
  buffer_load_dwordx4 v[28:31], v1, s[8:11], s40 offen nt
  buffer_load_dwordx4 v[48:51], v1, s[12:15], s40 offen nt
  buffer_load_dwordx2 v[64:65], v2, s[16:19], s42 offen nt
  s_add_u32 s40, s40, 16384
  s_add_u32 s42, s42, 8192
  buffer_load_dwordx4 v[32:35], v1, s[8:11], s40 offen nt
  buffer_load_dwordx4 v[52:55], v1, s[12:15], s40 offen nt
  buffer_load_dwordx2 v[66:67], v2, s[16:19], s42 offen nt
  s_add_u32 s40, s40, 16384
  s_add_u32 s42, s42, 8192
  buffer_load_dwordx4 v[36:39], v1, s[8:11], s40 offen nt
  buffer_load_dwordx4 v[56:59], v1, s[12:15], s40 offen nt
  buffer_load_dwordx2 v[68:69], v2, s[16:19], s42 offen nt
  s_waitcnt lgkmcnt(0)
  s_lshl_b32 s31, s31, 16
  s_barrier
  s_waitcnt vmcnt(12)
  v_mul_hi_u32_u24 v12, s28, v20
  v_mul_hi_u32_u24 v13, s30, v40
  v_mad_i32_i24 v14, v12, s29, v20
  v_lshlrev_b32 v12, 2, v12
  v_lshl_or_b32 v20, v13, 10, v12
  v_lshl_or_b32 v40, v40, 5, s32
  v_lshlrev_b32 v15, 20, v14
  v_lshlrev_b32 v14, 1, v14
  v_and_or_b32 v40, v15, s37, v40
  v_and_or_b32 v40, v14, 30, v40
  ds_add_rtn_u32 v4, v20, v3 offset:0
  v_mul_hi_u32_u24 v12, s28, v21
  v_mul_hi_u32_u24 v13, s30, v41
  v_mad_i32_i24 v14, v12, s29, v21
  v_lshlrev_b32 v12, 2, v12
  v_lshl_or_b32 v21, v13, 10, v12
  v_lshl_or_b32 v41, v41, 5, s32
  v_lshlrev_b32 v15, 20, v14
  v_lshlrev_b32 v14, 1, v14
  v_and_or_b32 v41, v15, s37, v41
  v_and_or_b32 v41, v14, 30, v41
  ds_add_rtn_u32 v5, v21, v3 offset:0
  v_mul_hi_u32_u24 v12, s28, v22
  v_mul_hi_u32_u24 v13, s30, v42
  v_mad_i32_i24 v14, v12, s29, v22
  v_lshlrev_b32 v12, 2, v12
  v_lshl_or_b32 v22, v13, 10, v12
  v_lshl_or_b32 v42, v42, 5, s32
  v_lshlrev_b32 v15, 20, v14
  v_lshlrev_b32 v14, 1, v14
  v_and_or_b32 v42, v15, s37, v42
  v_and_or_b32 v42, v14, 30, v42
  ds_add_rtn_u32 v6, v22, v3 offset:0
  v_mul_hi_u32_u24 v12, s28, v23
  v_mul_hi_u32_u24 v13, s30, v43
  v_mad_i32_i24 v14, v12, s29, v23
  v_lshlrev_b32 v12, 2, v12
  v_lshl_or_b32 v23, v13, 10, v12
  v_lshl_or_b32 v43, v43, 5, s32
  v_lshlrev_b32 v15, 20, v14
  v_lshlrev_b32 v14, 1, v14
  v_and_or_b32 v43, v15, s37, v43
  v_and_or_b32 v43, v14, 30, v43
  ds_add_rtn_u32 v7, v23, v3 offset:0
  v_lshlrev_b32 v12, 16, v60
  v_and_b32 v13, s38, v60
  v_mul_f32 v12, s31, v12
  v_mul_f32 v13, s31, v13
  v_cvt_pk_bf16_f32 v14, v12, v13
  v_lshlrev_b32 v12, 16, v14
  v_and_b32 v13, s38, v14
  v_mul_f32 v14, s33, v12
  v_mul_f32 v15, s33, v13
  v_fract_f32 v14, v14
  v_fract_f32 v15, v15
  v_fma_f32 v14, v12, s34, v14
  v_fma_f32 v15, v13, s34, v15
  v_cos_f32 v14, v14
  v_cos_f32 v15, v15
  s_nop 0
  v_cvt_pk_bf16_f32 v60, v14, v15
  v_lshlrev_b32 v12, 16, v61
  v_and_b32 v13, s38, v61
  v_mul_f32 v12, s31, v12
  v_mul_f32 v13, s31, v13
  v_cvt_pk_bf16_f32 v14, v12, v13
  v_lshlrev_b32 v12, 16, v14
  v_and_b32 v13, s38, v14
  v_mul_f32 v14, s33, v12
  v_mul_f32 v15, s33, v13
  v_fract_f32 v14, v14
  v_fract_f32 v15, v15
  v_fma_f32 v14, v12, s34, v14
  v_fma_f32 v15, v13, s34, v15
  v_cos_f32 v14, v14
  v_cos_f32 v15, v15
  s_nop 0
  v_cvt_pk_bf16_f32 v61, v14, v15
  s_waitcnt vmcnt(9)
  v_mul_hi_u32_u24 v12, s28, v24
  v_mul_hi_u32_u24 v13, s30, v44
  v_mad_i32_i24 v14, v12, s29, v24
  v_lshlrev_b32 v12, 2, v12
  v_lshl_or_b32 v24, v13, 10, v12
  v_lshl_or_b32 v44, v44, 5, s32
  v_lshlrev_b32 v15, 20, v14
  v_lshlrev_b32 v14, 1, v14
  v_and_or_b32 v44, v15, s37, v44
  v_and_or_b32 v44, v14, 30, v44
  ds_add_rtn_u32 v8, v24, v3 offset:0
  v_mul_hi_u32_u24 v12, s28, v25
  v_mul_hi_u32_u24 v13, s30, v45
  v_mad_i32_i24 v14, v12, s29, v25
  v_lshlrev_b32 v12, 2, v12
  v_lshl_or_b32 v25, v13, 10, v12
  v_lshl_or_b32 v45, v45, 5, s32
  v_lshlrev_b32 v15, 20, v14
  v_lshlrev_b32 v14, 1, v14
  v_and_or_b32 v45, v15, s37, v45
  v_and_or_b32 v45, v14, 30, v45
  ds_add_rtn_u32 v9, v25, v3 offset:0
  v_mul_hi_u32_u24 v12, s28, v26
  v_mul_hi_u32_u24 v13, s30, v46
  v_mad_i32_i24 v14, v12, s29, v26
  v_lshlrev_b32 v12, 2, v12
  v_lshl_or_b32 v26, v13, 10, v12
  v_lshl_or_b32 v46, v46, 5, s32
  v_lshlrev_b32 v15, 20, v14
  v_lshlrev_b32 v14, 1, v14
  v_and_or_b32 v46, v15, s37, v46
  v_and_or_b32 v46, v14, 30, v46
  ds_add_rtn_u32 v10, v26, v3 offset:0
  v_mul_hi_u32_u24 v12, s28, v27
  v_mul_hi_u32_u24 v13, s30, v47
  v_mad_i32_i24 v14, v12, s29, v27
  v_lshlrev_b32 v12, 2, v12
  v_lshl_or_b32 v27, v13, 10, v12
  v_lshl_or_b32 v47, v47, 5, s32
  v_lshlrev_b32 v15, 20, v14
  v_lshlrev_b32 v14, 1, v14
  v_and_or_b32 v47, v15, s37, v47
  v_and_or_b32 v47, v14, 30, v47
  ds_add_rtn_u32 v11, v27, v3 offset:0
  v_lshlrev_b32 v12, 16, v62
  v_and_b32 v13, s38, v62
  v_mul_f32 v12, s31, v12
  v_mul_f32 v13, s31, v13
  v_cvt_pk_bf16_f32 v14, v12, v13
  v_lshlrev_b32 v12, 16, v14
  v_and_b32 v13, s38, v14
  v_mul_f32 v14, s33, v12
  v_mul_f32 v15, s33, v13
  v_fract_f32 v14, v14
  v_fract_f32 v15, v15
  v_fma_f32 v14, v12, s34, v14
  v_fma_f32 v15, v13, s34, v15
  v_cos_f32 v14, v14
  v_cos_f32 v15, v15
  s_nop 0
  v_cvt_pk_bf16_f32 v62, v14, v15
  v_lshlrev_b32 v12, 16, v63
  v_and_b32 v13, s38, v63
  v_mul_f32 v12, s31, v12
  v_mul_f32 v13, s31, v13
  v_cvt_pk_bf16_f32 v14, v12, v13
  v_lshlrev_b32 v12, 16, v14
  v_and_b32 v13, s38, v14
  v_mul_f32 v14, s33, v12
  v_mul_f32 v15, s33, v13
  v_fract_f32 v14, v14
  v_fract_f32 v15, v15
  v_fma_f32 v14, v12, s34, v14
  v_fma_f32 v15, v13, s34, v15
  v_cos_f32 v14, v14
  v_cos_f32 v15, v15
  s_nop 0
  v_cvt_pk_bf16_f32 v63, v14, v15
  s_waitcnt lgkmcnt(4)
  v_lshl_or_b32 v20, v4, 12, v20
  v_lshl_or_b32 v21, v5, 12, v21
  v_lshl_or_b32 v22, v6, 12, v22
  v_lshl_or_b32 v23, v7, 12, v23
  s_waitcnt vmcnt(6)
  s_mul_i32 s40, s36, 81920
  s_mul_i32 s42, s36, 40960
  buffer_load_dwordx4 v[70:73], v1, s[8:11], s40 offen nt
  buffer_load_dwordx4 v[90:93], v1, s[12:15], s40 offen nt
  buffer_load_dwordx2 v[110:111], v2, s[16:19], s42 offen nt
  s_add_u32 s40, s40, 16384
  s_add_u32 s42, s42, 8192
  buffer_load_dwordx4 v[74:77], v1, s[8:11], s40 offen nt
  buffer_load_dwordx4 v[94:97], v1, s[12:15], s40 offen nt
  buffer_load_dwordx2 v[112:113], v2, s[16:19], s42 offen nt
  s_add_u32 s40, s40, 16384
  s_add_u32 s42, s42, 8192
  buffer_load_dwordx4 v[78:81], v1, s[8:11], s40 offen nt
  buffer_load_dwordx4 v[98:101], v1, s[12:15], s40 offen nt
  buffer_load_dwordx2 v[114:115], v2, s[16:19], s42 offen nt
  s_add_u32 s40, s40, 16384
  s_add_u32 s42, s42, 8192
  buffer_load_dwordx4 v[82:85], v1, s[8:11], s40 offen nt
  buffer_load_dwordx4 v[102:105], v1, s[12:15], s40 offen nt
  buffer_load_dwordx2 v[116:117], v2, s[16:19], s42 offen nt
  s_add_u32 s40, s40, 16384
  s_add_u32 s42, s42, 8192
  buffer_load_dwordx4 v[86:89], v1, s[8:11], s40 offen nt
  buffer_load_dwordx4 v[106:109], v1, s[12:15], s40 offen nt
  buffer_load_dwordx2 v[118:119], v2, s[16:19], s42 offen nt
  v_mul_hi_u32_u24 v12, s28, v28
  v_mul_hi_u32_u24 v13, s30, v48
  v_mad_i32_i24 v14, v12, s29, v28
  v_lshlrev_b32 v12, 2, v12
  v_lshl_or_b32 v28, v13, 10, v12
  v_lshl_or_b32 v48, v48, 5, s32
  v_lshlrev_b32 v15, 20, v14
  v_lshlrev_b32 v14, 1, v14
  v_and_or_b32 v48, v15, s37, v48
  v_and_or_b32 v48, v14, 30, v48
  ds_add_rtn_u32 v4, v28, v3 offset:0
  v_mul_hi_u32_u24 v12, s28, v29
  v_mul_hi_u32_u24 v13, s30, v49
  v_mad_i32_i24 v14, v12, s29, v29
  v_lshlrev_b32 v12, 2, v12
  v_lshl_or_b32 v29, v13, 10, v12
  v_lshl_or_b32 v49, v49, 5, s32
  v_lshlrev_b32 v15, 20, v14
  v_lshlrev_b32 v14, 1, v14
  v_and_or_b32 v49, v15, s37, v49
  v_and_or_b32 v49, v14, 30, v49
  ds_add_rtn_u32 v5, v29, v3 offset:0
  v_mul_hi_u32_u24 v12, s28, v30
  v_mul_hi_u32_u24 v13, s30, v50
  v_mad_i32_i24 v14, v12, s29, v30
  v_lshlrev_b32 v12, 2, v12
  v_lshl_or_b32 v30, v13, 10, v12
  v_lshl_or_b32 v50, v50, 5, s32
  v_lshlrev_b32 v15, 20, v14
  v_lshlrev_b32 v14, 1, v14
  v_and_or_b32 v50, v15, s37, v50
  v_and_or_b32 v50, v14, 30, v50
  ds_add_rtn_u32 v6, v30, v3 offset:0
  v_mul_hi_u32_u24 v12, s28, v31
  v_mul_hi_u32_u24 v13, s30, v51
  v_mad_i32_i24 v14, v12, s29, v31
  v_lshlrev_b32 v12, 2, v12
  v_lshl_or_b32 v31, v13, 10, v12
  v_lshl_or_b32 v51, v51, 5, s32
  v_lshlrev_b32 v15, 20, v14
  v_lshlrev_b32 v14, 1, v14
  v_and_or_b32 v51, v15, s37, v51
  v_and_or_b32 v51, v14, 30, v51
  ds_add_rtn_u32 v7, v31, v3 offset:0
  v_lshlrev_b32 v12, 16, v64
  v_and_b32 v13, s38, v64
  v_mul_f32 v12, s31, v12
  v_mul_f32 v13, s31, v13
  v_cvt_pk_bf16_f32 v14, v12, v13
  v_lshlrev_b32 v12, 16, v14
  v_and_b32 v13, s38, v14
  v_mul_f32 v14, s33, v12
  v_mul_f32 v15, s33, v13
  v_fract_f32 v14, v14
  v_fract_f32 v15, v15
  v_fma_f32 v14, v12, s34, v14
  v_fma_f32 v15, v13, s34, v15
  v_cos_f32 v14, v14
  v_cos_f32 v15, v15
  s_nop 0
  v_cvt_pk_bf16_f32 v64, v14, v15
  v_lshlrev_b32 v12, 16, v65
  v_and_b32 v13, s38, v65
  v_mul_f32 v12, s31, v12
  v_mul_f32 v13, s31, v13
  v_cvt_pk_bf16_f32 v14, v12, v13
  v_lshlrev_b32 v12, 16, v14
  v_and_b32 v13, s38, v14
  v_mul_f32 v14, s33, v12
  v_mul_f32 v15, s33, v13
  v_fract_f32 v14, v14
  v_fract_f32 v15, v15
  v_fma_f32 v14, v12, s34, v14
  v_fma_f32 v15, v13, s34, v15
  v_cos_f32 v14, v14
  v_cos_f32 v15, v15
  s_nop 0
  v_cvt_pk_bf16_f32 v65, v14, v15
  s_waitcnt lgkmcnt(4)
  v_lshl_or_b32 v24, v8, 12, v24
  v_lshl_or_b32 v25, v9, 12, v25
  v_lshl_or_b32 v26, v10, 12, v26
  v_lshl_or_b32 v27, v11, 12, v27
  s_waitcnt vmcnt(18)
  v_mul_hi_u32_u24 v12, s28, v32
  v_mul_hi_u32_u24 v13, s30, v52
  v_mad_i32_i24 v14, v12, s29, v32
  v_lshlrev_b32 v12, 2, v12
  v_lshl_or_b32 v32, v13, 10, v12
  v_lshl_or_b32 v52, v52, 5, s32
  v_lshlrev_b32 v15, 20, v14
  v_lshlrev_b32 v14, 1, v14
  v_and_or_b32 v52, v15, s37, v52
  v_and_or_b32 v52, v14, 30, v52
  ds_add_rtn_u32 v8, v32, v3 offset:0
  v_mul_hi_u32_u24 v12, s28, v33
  v_mul_hi_u32_u24 v13, s30, v53
  v_mad_i32_i24 v14, v12, s29, v33
  v_lshlrev_b32 v12, 2, v12
  v_lshl_or_b32 v33, v13, 10, v12
  v_lshl_or_b32 v53, v53, 5, s32
  v_lshlrev_b32 v15, 20, v14
  v_lshlrev_b32 v14, 1, v14
  v_and_or_b32 v53, v15, s37, v53
  v_and_or_b32 v53, v14, 30, v53
  ds_add_rtn_u32 v9, v33, v3 offset:0
  v_mul_hi_u32_u24 v12, s28, v34
  v_mul_hi_u32_u24 v13, s30, v54
  v_mad_i32_i24 v14, v12, s29, v34
  v_lshlrev_b32 v12, 2, v12
  v_lshl_or_b32 v34, v13, 10, v12
  v_lshl_or_b32 v54, v54, 5, s32
  v_lshlrev_b32 v15, 20, v14
  v_lshlrev_b32 v14, 1, v14
  v_and_or_b32 v54, v15, s37, v54
  v_and_or_b32 v54, v14, 30, v54
  ds_add_rtn_u32 v10, v34, v3 offset:0
  v_mul_hi_u32_u24 v12, s28, v35
  v_mul_hi_u32_u24 v13, s30, v55
  v_mad_i32_i24 v14, v12, s29, v35
  v_lshlrev_b32 v12, 2, v12
  v_lshl_or_b32 v35, v13, 10, v12
  v_lshl_or_b32 v55, v55, 5, s32
  v_lshlrev_b32 v15, 20, v14
  v_lshlrev_b32 v14, 1, v14
  v_and_or_b32 v55, v15, s37, v55
  v_and_or_b32 v55, v14, 30, v55
  ds_add_rtn_u32 v11, v35, v3 offset:0
  v_lshlrev_b32 v12, 16, v66
  v_and_b32 v13, s38, v66
  v_mul_f32 v12, s31, v12
  v_mul_f32 v13, s31, v13
  v_cvt_pk_bf16_f32 v14, v12, v13
  v_lshlrev_b32 v12, 16, v14
  v_and_b32 v13, s38, v14
  v_mul_f32 v14, s33, v12
  v_mul_f32 v15, s33, v13
  v_fract_f32 v14, v14
  v_fract_f32 v15, v15
  v_fma_f32 v14, v12, s34, v14
  v_fma_f32 v15, v13, s34, v15
  v_cos_f32 v14, v14
  v_cos_f32 v15, v15
  s_nop 0
  v_cvt_pk_bf16_f32 v66, v14, v15
  v_lshlrev_b32 v12, 16, v67
  v_and_b32 v13, s38, v67
  v_mul_f32 v12, s31, v12
  v_mul_f32 v13, s31, v13
  v_cvt_pk_bf16_f32 v14, v12, v13
  v_lshlrev_b32 v12, 16, v14
  v_and_b32 v13, s38, v14
  v_mul_f32 v14, s33, v12
  v_mul_f32 v15, s33, v13
  v_fract_f32 v14, v14
  v_fract_f32 v15, v15
  v_fma_f32 v14, v12, s34, v14
  v_fma_f32 v15, v13, s34, v15
  v_cos_f32 v14, v14
  v_cos_f32 v15, v15
  s_nop 0
  v_cvt_pk_bf16_f32 v67, v14, v15
  s_waitcnt lgkmcnt(4)
  v_lshl_or_b32 v28, v4, 12, v28
  v_lshl_or_b32 v29, v5, 12, v29
  v_lshl_or_b32 v30, v6, 12, v30
  v_lshl_or_b32 v31, v7, 12, v31
  s_waitcnt vmcnt(15)
  v_mul_hi_u32_u24 v12, s28, v36
  v_mul_hi_u32_u24 v13, s30, v56
  v_mad_i32_i24 v14, v12, s29, v36
  v_lshlrev_b32 v12, 2, v12
  v_lshl_or_b32 v36, v13, 10, v12
  v_lshl_or_b32 v56, v56, 5, s32
  v_lshlrev_b32 v15, 20, v14
  v_lshlrev_b32 v14, 1, v14
  v_and_or_b32 v56, v15, s37, v56
  v_and_or_b32 v56, v14, 30, v56
  ds_add_rtn_u32 v4, v36, v3 offset:0
  v_mul_hi_u32_u24 v12, s28, v37
  v_mul_hi_u32_u24 v13, s30, v57
  v_mad_i32_i24 v14, v12, s29, v37
  v_lshlrev_b32 v12, 2, v12
  v_lshl_or_b32 v37, v13, 10, v12
  v_lshl_or_b32 v57, v57, 5, s32
  v_lshlrev_b32 v15, 20, v14
  v_lshlrev_b32 v14, 1, v14
  v_and_or_b32 v57, v15, s37, v57
  v_and_or_b32 v57, v14, 30, v57
  ds_add_rtn_u32 v5, v37, v3 offset:0
  v_mul_hi_u32_u24 v12, s28, v38
  v_mul_hi_u32_u24 v13, s30, v58
  v_mad_i32_i24 v14, v12, s29, v38
  v_lshlrev_b32 v12, 2, v12
  v_lshl_or_b32 v38, v13, 10, v12
  v_lshl_or_b32 v58, v58, 5, s32
  v_lshlrev_b32 v15, 20, v14
  v_lshlrev_b32 v14, 1, v14
  v_and_or_b32 v58, v15, s37, v58
  v_and_or_b32 v58, v14, 30, v58
  ds_add_rtn_u32 v6, v38, v3 offset:0
  v_mul_hi_u32_u24 v12, s28, v39
  v_mul_hi_u32_u24 v13, s30, v59
  v_mad_i32_i24 v14, v12, s29, v39
  v_lshlrev_b32 v12, 2, v12
  v_lshl_or_b32 v39, v13, 10, v12
  v_lshl_or_b32 v59, v59, 5, s32
  v_lshlrev_b32 v15, 20, v14
  v_lshlrev_b32 v14, 1, v14
  v_and_or_b32 v59, v15, s37, v59
  v_and_or_b32 v59, v14, 30, v59
  ds_add_rtn_u32 v7, v39, v3 offset:0
  v_lshlrev_b32 v12, 16, v68
  v_and_b32 v13, s38, v68
  v_mul_f32 v12, s31, v12
  v_mul_f32 v13, s31, v13
  v_cvt_pk_bf16_f32 v14, v12, v13
  v_lshlrev_b32 v12, 16, v14
  v_and_b32 v13, s38, v14
  v_mul_f32 v14, s33, v12
  v_mul_f32 v15, s33, v13
  v_fract_f32 v14, v14
  v_fract_f32 v15, v15
  v_fma_f32 v14, v12, s34, v14
  v_fma_f32 v15, v13, s34, v15
  v_cos_f32 v14, v14
  v_cos_f32 v15, v15
  s_nop 0
  v_cvt_pk_bf16_f32 v68, v14, v15
  v_lshlrev_b32 v12, 16, v69
  v_and_b32 v13, s38, v69
  v_mul_f32 v12, s31, v12
  v_mul_f32 v13, s31, v13
  v_cvt_pk_bf16_f32 v14, v12, v13
  v_lshlrev_b32 v12, 16, v14
  v_and_b32 v13, s38, v14
  v_mul_f32 v14, s33, v12
  v_mul_f32 v15, s33, v13
  v_fract_f32 v14, v14
  v_fract_f32 v15, v15
  v_fma_f32 v14, v12, s34, v14
  v_fma_f32 v15, v13, s34, v15
  v_cos_f32 v14, v14
  v_cos_f32 v15, v15
  s_nop 0
  v_cvt_pk_bf16_f32 v69, v14, v15
  s_waitcnt lgkmcnt(4)
  v_lshl_or_b32 v32, v8, 12, v32
  v_lshl_or_b32 v33, v9, 12, v33
  v_lshl_or_b32 v34, v10, 12, v34
  v_lshl_or_b32 v35, v11, 12, v35
  s_waitcnt lgkmcnt(0)
  v_lshl_or_b32 v36, v4, 12, v36
  v_lshl_or_b32 v37, v5, 12, v37
  v_lshl_or_b32 v38, v6, 12, v38
  v_lshl_or_b32 v39, v7, 12, v39
  s_barrier
  ds_read_b32 v4, v16 offset:0
  s_waitcnt lgkmcnt(0)
  v_add_u32 v5, 1, v4
  v_and_b32 v5, -2, v5
  v_mov_b32 v6, v5
  s_nop 1
  v_add_u32_dpp v6, v6, v6 row_shr:1 row_mask:0xf bank_mask:0xf bound_ctrl:0
  s_nop 1
  v_add_u32_dpp v6, v6, v6 row_shr:2 row_mask:0xf bank_mask:0xf bound_ctrl:0
  s_nop 1
  v_add_u32_dpp v6, v6, v6 row_shr:4 row_mask:0xf bank_mask:0xf bound_ctrl:0
  s_nop 1
  v_add_u32_dpp v6, v6, v6 row_shr:8 row_mask:0xf bank_mask:0xf bound_ctrl:0
  s_nop 1
  v_add_u32_dpp v6, v6, v6 row_bcast:15 row_mask:0xa bank_mask:0xf
  s_nop 1
  v_add_u32_dpp v6, v6, v6 row_bcast:31 row_mask:0xc bank_mask:0xf
  s_nop 1
  v_readlane_b32 s43, v6, 63
  s_lshl_b32 s44, s35, 2
  v_mov_b32 v7, s44
  s_nop 0
  v_mov_b32 v8, s43
  ds_write_b32 v7, v8 offset:4096
  s_waitcnt lgkmcnt(0)
  s_barrier
  ds_read_b32 v7, v17 offset:4096
  s_waitcnt lgkmcnt(0)
  s_nop 1
  v_add_u32_dpp v7, v7, v7 row_shr:1 row_mask:0xf bank_mask:0xf bound_ctrl:0
  s_nop 1
  v_add_u32_dpp v7, v7, v7 row_shr:2 row_mask:0xf bank_mask:0xf bound_ctrl:0
  s_nop 1
  v_add_u32_dpp v7, v7, v7 row_shr:4 row_mask:0xf bank_mask:0xf bound_ctrl:0
  s_nop 1
  v_add_u32_dpp v7, v7, v7 row_shr:8 row_mask:0xf bank_mask:0xf bound_ctrl:0
  s_nop 1
  s_sub_u32 s44, s35, 1
  s_max_i32 s44, s44, 0
  v_readlane_b32 s43, v7, s44
  s_cmp_eq_u32 s35, 0
  s_cselect_b32 s43, 0, s43
  v_sub_u32 v6, v6, v5
  s_nop 1
  v_add_u32 v6, s43, v6
  ds_write_b32 v16, v6 offset:0
  v_add_u32 v7, v6, v5
  v_lshrrev_b32 v8, 1, v6
  v_lshrrev_b32 v7, 1, v7
  v_lshl_or_b32 v7, v7, 16, v8
  s_lshl_b32 s44, s3, 2
  buffer_store_dword v7, v18, s[24:27], s44 offen
  v_and_b32 v8, 1, v4
  v_cmp_eq_u32 vcc, 1, v8
  v_add_u32 v8, v6, v4
  v_mul_u32_u24 v8, 6, v8
  v_mov_b32 v9, 0
  s_and_saveexec_b64 s[46:47], vcc
  ds_write_b32 v8, v9 offset:4222
  s_mov_b64 exec, s[46:47]
  s_waitcnt lgkmcnt(0)
  s_barrier
  v_and_b32 v4, s39, v20
  ds_read_b32 v4, v4 offset:0
  v_and_b32 v5, s39, v21
  ds_read_b32 v5, v5 offset:0
  v_and_b32 v6, s39, v22
  ds_read_b32 v6, v6 offset:0
  v_and_b32 v7, s39, v23
  ds_read_b32 v7, v7 offset:0
  v_and_b32 v8, s39, v24
  ds_read_b32 v8, v8 offset:0
  v_and_b32 v9, s39, v25
  ds_read_b32 v9, v9 offset:0
  v_and_b32 v10, s39, v26
  ds_read_b32 v10, v10 offset:0
  v_and_b32 v11, s39, v27
  ds_read_b32 v11, v11 offset:0
  s_waitcnt lgkmcnt(4)
  v_lshrrev_b32 v12, 12, v20
  v_add_u32 v12, v12, v4
  v_and_b32 v13, 1, v12
  v_mul_u32_u24 v12, 6, v12
  v_mad_i32_i24 v12, v13, -2, v12
  v_mad_i32_i24 v13, v13, -2, v12
  ds_write_b32 v12, v40 offset:4224
  ds_write_b16 v13, v60 offset:4232
  v_lshrrev_b32 v12, 12, v21
  v_add_u32 v12, v12, v5
  v_and_b32 v13, 1, v12
  v_mul_u32_u24 v12, 6, v12
  v_mad_i32_i24 v12, v13, -2, v12
  v_mad_i32_i24 v13, v13, -2, v12
  ds_write_b32 v12, v41 offset:4224
  ds_write_b16_d16_hi v13, v60 offset:4232
  v_lshrrev_b32 v12, 12, v22
  v_add_u32 v12, v12, v6
  v_and_b32 v13, 1, v12
  v_mul_u32_u24 v12, 6, v12
  v_mad_i32_i24 v12, v13, -2, v12
  v_mad_i32_i24 v13, v13, -2, v12
  ds_write_b32 v12, v42 offset:4224
  ds_write_b16 v13, v61 offset:4232
  v_lshrrev_b32 v12, 12, v23
  v_add_u32 v12, v12, v7
  v_and_b32 v13, 1, v12
  v_mul_u32_u24 v12, 6, v12
  v_mad_i32_i24 v12, v13, -2, v12
  v_mad_i32_i24 v13, v13, -2, v12
  ds_write_b32 v12, v43 offset:4224
  ds_write_b16_d16_hi v13, v61 offset:4232
  v_and_b32 v4, s39, v28
  ds_read_b32 v4, v4 offset:0
  v_and_b32 v5, s39, v29
  ds_read_b32 v5, v5 offset:0
  v_and_b32 v6, s39, v30
  ds_read_b32 v6, v6 offset:0
  v_and_b32 v7, s39, v31
  ds_read_b32 v7, v7 offset:0
  s_waitcnt lgkmcnt(4)
  v_lshrrev_b32 v12, 12, v24
  v_add_u32 v12, v12, v8
  v_and_b32 v13, 1, v12
  v_mul_u32_u24 v12, 6, v12
  v_mad_i32_i24 v12, v13, -2, v12
  v_mad_i32_i24 v13, v13, -2, v12
  ds_write_b32 v12, v44 offset:4224
  ds_write_b16 v13, v62 offset:4232
  v_lshrrev_b32 v12, 12, v25
  v_add_u32 v12, v12, v9
  v_and_b32 v13, 1, v12
  v_mul_u32_u24 v12, 6, v12
  v_mad_i32_i24 v12, v13, -2, v12
  v_mad_i32_i24 v13, v13, -2, v12
  ds_write_b32 v12, v45 offset:4224
  ds_write_b16_d16_hi v13, v62 offset:4232
  v_lshrrev_b32 v12, 12, v26
  v_add_u32 v12, v12, v10
  v_and_b32 v13, 1, v12
  v_mul_u32_u24 v12, 6, v12
  v_mad_i32_i24 v12, v13, -2, v12
  v_mad_i32_i24 v13, v13, -2, v12
  ds_write_b32 v12, v46 offset:4224
  ds_write_b16 v13, v63 offset:4232
  v_lshrrev_b32 v12, 12, v27
  v_add_u32 v12, v12, v11
  v_and_b32 v13, 1, v12
  v_mul_u32_u24 v12, 6, v12
  v_mad_i32_i24 v12, v13, -2, v12
  v_mad_i32_i24 v13, v13, -2, v12
  ds_write_b32 v12, v47 offset:4224
  ds_write_b16_d16_hi v13, v63 offset:4232
  v_and_b32 v8, s39, v32
  ds_read_b32 v8, v8 offset:0
  v_and_b32 v9, s39, v33
  ds_read_b32 v9, v9 offset:0
  v_and_b32 v10, s39, v34
  ds_read_b32 v10, v10 offset:0
  v_and_b32 v11, s39, v35
  ds_read_b32 v11, v11 offset:0
  s_waitcnt lgkmcnt(4)
  v_lshrrev_b32 v12, 12, v28
  v_add_u32 v12, v12, v4
  v_and_b32 v13, 1, v12
  v_mul_u32_u24 v12, 6, v12
  v_mad_i32_i24 v12, v13, -2, v12
  v_mad_i32_i24 v13, v13, -2, v12
  ds_write_b32 v12, v48 offset:4224
  ds_write_b16 v13, v64 offset:4232
  v_lshrrev_b32 v12, 12, v29
  v_add_u32 v12, v12, v5
  v_and_b32 v13, 1, v12
  v_mul_u32_u24 v12, 6, v12
  v_mad_i32_i24 v12, v13, -2, v12
  v_mad_i32_i24 v13, v13, -2, v12
  ds_write_b32 v12, v49 offset:4224
  ds_write_b16_d16_hi v13, v64 offset:4232
  v_lshrrev_b32 v12, 12, v30
  v_add_u32 v12, v12, v6
  v_and_b32 v13, 1, v12
  v_mul_u32_u24 v12, 6, v12
  v_mad_i32_i24 v12, v13, -2, v12
  v_mad_i32_i24 v13, v13, -2, v12
  ds_write_b32 v12, v50 offset:4224
  ds_write_b16 v13, v65 offset:4232
  v_lshrrev_b32 v12, 12, v31
  v_add_u32 v12, v12, v7
  v_and_b32 v13, 1, v12
  v_mul_u32_u24 v12, 6, v12
  v_mad_i32_i24 v12, v13, -2, v12
  v_mad_i32_i24 v13, v13, -2, v12
  ds_write_b32 v12, v51 offset:4224
  ds_write_b16_d16_hi v13, v65 offset:4232
  v_and_b32 v4, s39, v36
  ds_read_b32 v4, v4 offset:0
  v_and_b32 v5, s39, v37
  ds_read_b32 v5, v5 offset:0
  v_and_b32 v6, s39, v38
  ds_read_b32 v6, v6 offset:0
  v_and_b32 v7, s39, v39
  ds_read_b32 v7, v7 offset:0
  s_waitcnt lgkmcnt(4)
  v_lshrrev_b32 v12, 12, v32
  v_add_u32 v12, v12, v8
  v_and_b32 v13, 1, v12
  v_mul_u32_u24 v12, 6, v12
  v_mad_i32_i24 v12, v13, -2, v12
  v_mad_i32_i24 v13, v13, -2, v12
  ds_write_b32 v12, v52 offset:4224
  ds_write_b16 v13, v66 offset:4232
  v_lshrrev_b32 v12, 12, v33
  v_add_u32 v12, v12, v9
  v_and_b32 v13, 1, v12
  v_mul_u32_u24 v12, 6, v12
  v_mad_i32_i24 v12, v13, -2, v12
  v_mad_i32_i24 v13, v13, -2, v12
  ds_write_b32 v12, v53 offset:4224
  ds_write_b16_d16_hi v13, v66 offset:4232
  v_lshrrev_b32 v12, 12, v34
  v_add_u32 v12, v12, v10
  v_and_b32 v13, 1, v12
  v_mul_u32_u24 v12, 6, v12
  v_mad_i32_i24 v12, v13, -2, v12
  v_mad_i32_i24 v13, v13, -2, v12
  ds_write_b32 v12, v54 offset:4224
  ds_write_b16 v13, v67 offset:4232
  v_lshrrev_b32 v12, 12, v35
  v_add_u32 v12, v12, v11
  v_and_b32 v13, 1, v12
  v_mul_u32_u24 v12, 6, v12
  v_mad_i32_i24 v12, v13, -2, v12
  v_mad_i32_i24 v13, v13, -2, v12
  ds_write_b32 v12, v55 offset:4224
  ds_write_b16_d16_hi v13, v67 offset:4232
  s_waitcnt lgkmcnt(0)
  v_lshrrev_b32 v12, 12, v36
  v_add_u32 v12, v12, v4
  v_and_b32 v13, 1, v12
  v_mul_u32_u24 v12, 6, v12
  v_mad_i32_i24 v12, v13, -2, v12
  v_mad_i32_i24 v13, v13, -2, v12
  ds_write_b32 v12, v56 offset:4224
  ds_write_b16 v13, v68 offset:4232
  v_lshrrev_b32 v12, 12, v37
  v_add_u32 v12, v12, v5
  v_and_b32 v13, 1, v12
  v_mul_u32_u24 v12, 6, v12
  v_mad_i32_i24 v12, v13, -2, v12
  v_mad_i32_i24 v13, v13, -2, v12
  ds_write_b32 v12, v57 offset:4224
  ds_write_b16_d16_hi v13, v68 offset:4232
  v_lshrrev_b32 v12, 12, v38
  v_add_u32 v12, v12, v6
  v_and_b32 v13, 1, v12
  v_mul_u32_u24 v12, 6, v12
  v_mad_i32_i24 v12, v13, -2, v12
  v_mad_i32_i24 v13, v13, -2, v12
  ds_write_b32 v12, v58 offset:4224
  ds_write_b16 v13, v69 offset:4232
  v_lshrrev_b32 v12, 12, v39
  v_add_u32 v12, v12, v7
  v_and_b32 v13, 1, v12
  v_mul_u32_u24 v12, 6, v12
  v_mad_i32_i24 v12, v13, -2, v12
  v_mad_i32_i24 v13, v13, -2, v12
  ds_write_b32 v12, v59 offset:4224
  ds_write_b16_d16_hi v13, v69 offset:4232
  s_waitcnt lgkmcnt(0)
  s_barrier
  v_mov_b32 v9, 0
  ds_write_b32 v16, v9 offset:0
  ds_read_b128 v[20:23], v1 offset:4224
  ds_read_b128 v[24:27], v1 offset:20608
  ds_read_b128 v[28:31], v1 offset:36992
  ds_read_b128 v[32:35], v19 offset:4224
  ds_read_b128 v[36:39], v19 offset:20608
  ds_read_b128 v[40:43], v19 offset:36992
  ds_read_b128 v[44:47], v19 offset:53376
  s_cmp_lt_u32 s35, 14
  s_cbranch_scc0 L_k1_skip7_a
  v_add_u32 v12, 65536, v19
  ds_read_b128 v[48:51], v12 offset:4224
L_k1_skip7_a:
  s_mul_i32 s44, s3, 129024
  s_waitcnt lgkmcnt(0)
  s_barrier
  buffer_store_dwordx4 v[20:23], v1, s[20:23], s44 offen sc0 sc1
  s_add_u32 s44, s44, 16384
  buffer_store_dwordx4 v[24:27], v1, s[20:23], s44 offen sc0 sc1
  s_add_u32 s44, s44, 16384
  buffer_store_dwordx4 v[28:31], v1, s[20:23], s44 offen sc0 sc1
  s_add_u32 s44, s44, 16384
  buffer_store_dwordx4 v[32:35], v1, s[20:23], s44 offen sc0 sc1
  s_add_u32 s44, s44, 16384
  buffer_store_dwordx4 v[36:39], v1, s[20:23], s44 offen sc0 sc1
  s_add_u32 s44, s44, 16384
  buffer_store_dwordx4 v[40:43], v1, s[20:23], s44 offen sc0 sc1
  s_add_u32 s44, s44, 16384
  buffer_store_dwordx4 v[44:47], v1, s[20:23], s44 offen sc0 sc1
  s_add_u32 s44, s44, 16384
  s_cmp_lt_u32 s35, 14
  s_cbranch_scc0 L_k1_skip7s_a
  buffer_store_dwordx4 v[48:51], v1, s[20:23], s44 offen sc0 sc1
L_k1_skip7s_a:
  s_cmp_ge_u32 s36, 500
  s_cbranch_scc1 L_k1_fin
  s_waitcnt vmcnt(8)
  v_mul_hi_u32_u24 v12, s28, v70
  v_mul_hi_u32_u24 v13, s30, v90
  v_mad_i32_i24 v14, v12, s29, v70
  v_lshlrev_b32 v12, 2, v12
  v_lshl_or_b32 v70, v13, 10, v12
  v_lshl_or_b32 v90, v90, 5, s32
  v_lshlrev_b32 v15, 20, v14
  v_lshlrev_b32 v14, 1, v14
  v_and_or_b32 v90, v15, s37, v90
  v_and_or_b32 v90, v14, 30, v90
  ds_add_rtn_u32 v4, v70, v3 offset:0
  v_mul_hi_u32_u24 v12, s28, v71
  v_mul_hi_u32_u24 v13, s30, v91
  v_mad_i32_i24 v14, v12, s29, v71
  v_lshlrev_b32 v12, 2, v12
  v_lshl_or_b32 v71, v13, 10, v12
  v_lshl_or_b32 v91, v91, 5, s32
  v_lshlrev_b32 v15, 20, v14
  v_lshlrev_b32 v14, 1, v14
  v_and_or_b32 v91, v15, s37, v91
  v_and_or_b32 v91, v14, 30, v91
  ds_add_rtn_u32 v5, v71, v3 offset:0
  v_mul_hi_u32_u24 v12, s28, v72
  v_mul_hi_u32_u24 v13, s30, v92
  v_mad_i32_i24 v14, v12, s29, v72
  v_lshlrev_b32 v12, 2, v12
  v_lshl_or_b32 v72, v13, 10, v12
  v_lshl_or_b32 v92, v92, 5, s32
  v_lshlrev_b32 v15, 20, v14
  v_lshlrev_b32 v14, 1, v14
  v_and_or_b32 v92, v15, s37, v92
  v_and_or_b32 v92, v14, 30, v92
  ds_add_rtn_u32 v6, v72, v3 offset:0
  v_mul_hi_u32_u24 v12, s28, v73
  v_mul_hi_u32_u24 v13, s30, v93
  v_mad_i32_i24 v14, v12, s29, v73
  v_lshlrev_b32 v12, 2, v12
  v_lshl_or_b32 v73, v13, 10, v12
  v_lshl_or_b32 v93, v93, 5, s32
  v_lshlrev_b32 v15, 20, v14
  v_lshlrev_b32 v14, 1, v14
  v_and_or_b32 v93, v15, s37, v93
  v_and_or_b32 v93, v14, 30, v93
  ds_add_rtn_u32 v7, v73, v3 offset:0
  v_lshlrev_b32 v12, 16, v110
  v_and_b32 v13, s38, v110
  v_mul_f32 v12, s31, v12
  v_mul_f32 v13, s31, v13
  v_cvt_pk_bf16_f32 v14, v12, v13
  v_lshlrev_b32 v12, 16, v14
  v_and_b32 v13, s38, v14
  v_mul_f32 v14, s33, v12
  v_mul_f32 v15, s33, v13
  v_fract_f32 v14, v14
  v_fract_f32 v15, v15
  v_fma_f32 v14, v12, s34, v14
  v_fma_f32 v15, v13, s34, v15
  v_cos_f32 v14, v14
  v_cos_f32 v15, v15
  s_nop 0
  v_cvt_pk_bf16_f32 v110, v14, v15
  v_lshlrev_b32 v12, 16, v111
  v_and_b32 v13, s38, v111
  v_mul_f32 v12, s31, v12
  v_mul_f32 v13, s31, v13
  v_cvt_pk_bf16_f32 v14, v12, v13
  v_lshlrev_b32 v12, 16, v14
  v_and_b32 v13, s38, v14
  v_mul_f32 v14, s33, v12
  v_mul_f32 v15, s33, v13
  v_fract_f32 v14, v14
  v_fract_f32 v15, v15
  v_fma_f32 v14, v12, s34, v14
  v_fma_f32 v15, v13, s34, v15
  v_cos_f32 v14, v14
  v_cos_f32 v15, v15
  s_nop 0
  v_cvt_pk_bf16_f32 v111, v14, v15
  v_mul_hi_u32_u24 v12, s28, v74
  v_mul_hi_u32_u24 v13, s30, v94
  v_mad_i32_i24 v14, v12, s29, v74
  v_lshlrev_b32 v12, 2, v12
  v_lshl_or_b32 v74, v13, 10, v12
  v_lshl_or_b32 v94, v94, 5, s32
  v_lshlrev_b32 v15, 20, v14
  v_lshlrev_b32 v14, 1, v14
  v_and_or_b32 v94, v15, s37, v94
  v_and_or_b32 v94, v14, 30, v94
  ds_add_rtn_u32 v8, v74, v3 offset:0
  v_mul_hi_u32_u24 v12, s28, v75
  v_mul_hi_u32_u24 v13, s30, v95
  v_mad_i32_i24 v14, v12, s29, v75
  v_lshlrev_b32 v12, 2, v12
  v_lshl_or_b32 v75, v13, 10, v12
  v_lshl_or_b32 v95, v95, 5, s32
  v_lshlrev_b32 v15, 20, v14
  v_lshlrev_b32 v14, 1, v14
  v_and_or_b32 v95, v15, s37, v95
  v_and_or_b32 v95, v14, 30, v95
  ds_add_rtn_u32 v9, v75, v3 offset:0
  v_mul_hi_u32_u24 v12, s28, v76
  v_mul_hi_u32_u24 v13, s30, v96
  v_mad_i32_i24 v14, v12, s29, v76
  v_lshlrev_b32 v12, 2, v12
  v_lshl_or_b32 v76, v13, 10, v12
  v_lshl_or_b32 v96, v96, 5, s32
  v_lshlrev_b32 v15, 20, v14
  v_lshlrev_b32 v14, 1, v14
  v_and_or_b32 v96, v15, s37, v96
  v_and_or_b32 v96, v14, 30, v96
  ds_add_rtn_u32 v10, v76, v3 offset:0
  v_mul_hi_u32_u24 v12, s28, v77
  v_mul_hi_u32_u24 v13, s30, v97
  v_mad_i32_i24 v14, v12, s29, v77
  v_lshlrev_b32 v12, 2, v12
  v_lshl_or_b32 v77, v13, 10, v12
  v_lshl_or_b32 v97, v97, 5, s32
  v_lshlrev_b32 v15, 20, v14
  v_lshlrev_b32 v14, 1, v14
  v_and_or_b32 v97, v15, s37, v97
  v_and_or_b32 v97, v14, 30, v97
  ds_add_rtn_u32 v11, v77, v3 offset:0
  v_lshlrev_b32 v12, 16, v112
  v_and_b32 v13, s38, v112
  v_mul_f32 v12, s31, v12
  v_mul_f32 v13, s31, v13
  v_cvt_pk_bf16_f32 v14, v12, v13
  v_lshlrev_b32 v12, 16, v14
  v_and_b32 v13, s38, v14
  v_mul_f32 v14, s33, v12
  v_mul_f32 v15, s33, v13
  v_fract_f32 v14, v14
  v_fract_f32 v15, v15
  v_fma_f32 v14, v12, s34, v14
  v_fma_f32 v15, v13, s34, v15
  v_cos_f32 v14, v14
  v_cos_f32 v15, v15
  s_nop 0
  v_cvt_pk_bf16_f32 v112, v14, v15
  v_lshlrev_b32 v12, 16, v113
  v_and_b32 v13, s38, v113
  v_mul_f32 v12, s31, v12
  v_mul_f32 v13, s31, v13
  v_cvt_pk_bf16_f32 v14, v12, v13
  v_lshlrev_b32 v12, 16, v14
  v_and_b32 v13, s38, v14
  v_mul_f32 v14, s33, v12
  v_mul_f32 v15, s33, v13
  v_fract_f32 v14, v14
  v_fract_f32 v15, v15
  v_fma_f32 v14, v12, s34, v14
  v_fma_f32 v15, v13, s34, v15
  v_cos_f32 v14, v14
  v_cos_f32 v15, v15
  s_nop 0
  v_cvt_pk_bf16_f32 v113, v14, v15
  s_waitcnt lgkmcnt(4)
  v_lshl_or_b32 v70, v4, 12, v70
  v_lshl_or_b32 v71, v5, 12, v71
  v_lshl_or_b32 v72, v6, 12, v72
  v_lshl_or_b32 v73, v7, 12, v73
  v_mul_hi_u32_u24 v12, s28, v78
  v_mul_hi_u32_u24 v13, s30, v98
  v_mad_i32_i24 v14, v12, s29, v78
  v_lshlrev_b32 v12, 2, v12
  v_lshl_or_b32 v78, v13, 10, v12
  v_lshl_or_b32 v98, v98, 5, s32
  v_lshlrev_b32 v15, 20, v14
  v_lshlrev_b32 v14, 1, v14
  v_and_or_b32 v98, v15, s37, v98
  v_and_or_b32 v98, v14, 30, v98
  ds_add_rtn_u32 v4, v78, v3 offset:0
  v_mul_hi_u32_u24 v12, s28, v79
  v_mul_hi_u32_u24 v13, s30, v99
  v_mad_i32_i24 v14, v12, s29, v79
  v_lshlrev_b32 v12, 2, v12
  v_lshl_or_b32 v79, v13, 10, v12
  v_lshl_or_b32 v99, v99, 5, s32
  v_lshlrev_b32 v15, 20, v14
  v_lshlrev_b32 v14, 1, v14
  v_and_or_b32 v99, v15, s37, v99
  v_and_or_b32 v99, v14, 30, v99
  ds_add_rtn_u32 v5, v79, v3 offset:0
  v_mul_hi_u32_u24 v12, s28, v80
  v_mul_hi_u32_u24 v13, s30, v100
  v_mad_i32_i24 v14, v12, s29, v80
  v_lshlrev_b32 v12, 2, v12
  v_lshl_or_b32 v80, v13, 10, v12
  v_lshl_or_b32 v100, v100, 5, s32
  v_lshlrev_b32 v15, 20, v14
  v_lshlrev_b32 v14, 1, v14
  v_and_or_b32 v100, v15, s37, v100
  v_and_or_b32 v100, v14, 30, v100
  ds_add_rtn_u32 v6, v80, v3 offset:0
  v_mul_hi_u32_u24 v12, s28, v81
  v_mul_hi_u32_u24 v13, s30, v101
  v_mad_i32_i24 v14, v12, s29, v81
  v_lshlrev_b32 v12, 2, v12
  v_lshl_or_b32 v81, v13, 10, v12
  v_lshl_or_b32 v101, v101, 5, s32
  v_lshlrev_b32 v15, 20, v14
  v_lshlrev_b32 v14, 1, v14
  v_and_or_b32 v101, v15, s37, v101
  v_and_or_b32 v101, v14, 30, v101
  ds_add_rtn_u32 v7, v81, v3 offset:0
  v_lshlrev_b32 v12, 16, v114
  v_and_b32 v13, s38, v114
  v_mul_f32 v12, s31, v12
  v_mul_f32 v13, s31, v13
  v_cvt_pk_bf16_f32 v14, v12, v13
  v_lshlrev_b32 v12, 16, v14
  v_and_b32 v13, s38, v14
  v_mul_f32 v14, s33, v12
  v_mul_f32 v15, s33, v13
  v_fract_f32 v14, v14
  v_fract_f32 v15, v15
  v_fma_f32 v14, v12, s34, v14
  v_fma_f32 v15, v13, s34, v15
  v_cos_f32 v14, v14
  v_cos_f32 v15, v15
  s_nop 0
  v_cvt_pk_bf16_f32 v114, v14, v15
  v_lshlrev_b32 v12, 16, v115
  v_and_b32 v13, s38, v115
  v_mul_f32 v12, s31, v12
  v_mul_f32 v13, s31, v13
  v_cvt_pk_bf16_f32 v14, v12, v13
  v_lshlrev_b32 v12, 16, v14
  v_and_b32 v13, s38, v14
  v_mul_f32 v14, s33, v12
  v_mul_f32 v15, s33, v13
  v_fract_f32 v14, v14
  v_fract_f32 v15, v15
  v_fma_f32 v14, v12, s34, v14
  v_fma_f32 v15, v13, s34, v15
  v_cos_f32 v14, v14
  v_cos_f32 v15, v15
  s_nop 0
  v_cvt_pk_bf16_f32 v115, v14, v15
  s_waitcnt lgkmcnt(4)
  v_lshl_or_b32 v74, v8, 12, v74
  v_lshl_or_b32 v75, v9, 12, v75
  v_lshl_or_b32 v76, v10, 12, v76
  v_lshl_or_b32 v77, v11, 12, v77
  v_mul_hi_u32_u24 v12, s28, v82
  v_mul_hi_u32_u24 v13, s30, v102
  v_mad_i32_i24 v14, v12, s29, v82
  v_lshlrev_b32 v12, 2, v12
  v_lshl_or_b32 v82, v13, 10, v12
  v_lshl_or_b32 v102, v102, 5, s32
  v_lshlrev_b32 v15, 20, v14
  v_lshlrev_b32 v14, 1, v14
  v_and_or_b32 v102, v15, s37, v102
  v_and_or_b32 v102, v14, 30, v102
  ds_add_rtn_u32 v8, v82, v3 offset:0
  v_mul_hi_u32_u24 v12, s28, v83
  v_mul_hi_u32_u24 v13, s30, v103
  v_mad_i32_i24 v14, v12, s29, v83
  v_lshlrev_b32 v12, 2, v12
  v_lshl_or_b32 v83, v13, 10, v12
  v_lshl_or_b32 v103, v103, 5, s32
  v_lshlrev_b32 v15, 20, v14
  v_lshlrev_b32 v14, 1, v14
  v_and_or_b32 v103, v15, s37, v103
  v_and_or_b32 v103, v14, 30, v103
  ds_add_rtn_u32 v9, v83, v3 offset:0
  v_mul_hi_u32_u24 v12, s28, v84
  v_mul_hi_u32_u24 v13, s30, v104
  v_mad_i32_i24 v14, v12, s29, v84
  v_lshlrev_b32 v12, 2, v12
  v_lshl_or_b32 v84, v13, 10, v12
  v_lshl_or_b32 v104, v104, 5, s32
  v_lshlrev_b32 v15, 20, v14
  v_lshlrev_b32 v14, 1, v14
  v_and_or_b32 v104, v15, s37, v104
  v_and_or_b32 v104, v14, 30, v104
  ds_add_rtn_u32 v10, v84, v3 offset:0
  v_mul_hi_u32_u24 v12, s28, v85
  v_mul_hi_u32_u24 v13, s30, v105
  v_mad_i32_i24 v14, v12, s29, v85
  v_lshlrev_b32 v12, 2, v12
  v_lshl_or_b32 v85, v13, 10, v12
  v_lshl_or_b32 v105, v105, 5, s32
  v_lshlrev_b32 v15, 20, v14
  v_lshlrev_b32 v14, 1, v14
  v_and_or_b32 v105, v15, s37, v105
  v_and_or_b32 v105, v14, 30, v105
  ds_add_rtn_u32 v11, v85, v3 offset:0
  v_lshlrev_b32 v12, 16, v116
  v_and_b32 v13, s38, v116
  v_mul_f32 v12, s31, v12
  v_mul_f32 v13, s31, v13
  v_cvt_pk_bf16_f32 v14, v12, v13
  v_lshlrev_b32 v12, 16, v14
  v_and_b32 v13, s38, v14
  v_mul_f32 v14, s33, v12
  v_mul_f32 v15, s33, v13
  v_fract_f32 v14, v14
  v_fract_f32 v15, v15
  v_fma_f32 v14, v12, s34, v14
  v_fma_f32 v15, v13, s34, v15
  v_cos_f32 v14, v14
  v_cos_f32 v15, v15
  s_nop 0
  v_cvt_pk_bf16_f32 v116, v14, v15
  v_lshlrev_b32 v12, 16, v117
  v_and_b32 v13, s38, v117
  v_mul_f32 v12, s31, v12
  v_mul_f32 v13, s31, v13
  v_cvt_pk_bf16_f32 v14, v12, v13
  v_lshlrev_b32 v12, 16, v14
  v_and_b32 v13, s38, v14
  v_mul_f32 v14, s33, v12
  v_mul_f32 v15, s33, v13
  v_fract_f32 v14, v14
  v_fract_f32 v15, v15
  v_fma_f32 v14, v12, s34, v14
  v_fma_f32 v15, v13, s34, v15
  v_cos_f32 v14, v14
  v_cos_f32 v15, v15
  s_nop 0
  v_cvt_pk_bf16_f32 v117, v14, v15
  s_waitcnt lgkmcnt(4)
  v_lshl_or_b32 v78, v4, 12, v78
  v_lshl_or_b32 v79, v5, 12, v79
  v_lshl_or_b32 v80, v6, 12, v80
  v_lshl_or_b32 v81, v7, 12, v81
  v_mul_hi_u32_u24 v12, s28, v86
  v_mul_hi_u32_u24 v13, s30, v106
  v_mad_i32_i24 v14, v12, s29, v86
  v_lshlrev_b32 v12, 2, v12
  v_lshl_or_b32 v86, v13, 10, v12
  v_lshl_or_b32 v106, v106, 5, s32
  v_lshlrev_b32 v15, 20, v14
  v_lshlrev_b32 v14, 1, v14
  v_and_or_b32 v106, v15, s37, v106
  v_and_or_b32 v106, v14, 30, v106
  ds_add_rtn_u32 v4, v86, v3 offset:0
  v_mul_hi_u32_u24 v12, s28, v87
  v_mul_hi_u32_u24 v13, s30, v107
  v_mad_i32_i24 v14, v12, s29, v87
  v_lshlrev_b32 v12, 2, v12
  v_lshl_or_b32 v87, v13, 10, v12
  v_lshl_or_b32 v107, v107, 5, s32
  v_lshlrev_b32 v15, 20, v14
  v_lshlrev_b32 v14, 1, v14
  v_and_or_b32 v107, v15, s37, v107
  v_and_or_b32 v107, v14, 30, v107
  ds_add_rtn_u32 v5, v87, v3 offset:0
  v_mul_hi_u32_u24 v12, s28, v88
  v_mul_hi_u32_u24 v13, s30, v108
  v_mad_i32_i24 v14, v12, s29, v88
  v_lshlrev_b32 v12, 2, v12
  v_lshl_or_b32 v88, v13, 10, v12
  v_lshl_or_b32 v108, v108, 5, s32
  v_lshlrev_b32 v15, 20, v14
  v_lshlrev_b32 v14, 1, v14
  v_and_or_b32 v108, v15, s37, v108
  v_and_or_b32 v108, v14, 30, v108
  ds_add_rtn_u32 v6, v88, v3 offset:0
  v_mul_hi_u32_u24 v12, s28, v89
  v_mul_hi_u32_u24 v13, s30, v109
  v_mad_i32_i24 v14, v12, s29, v89
  v_lshlrev_b32 v12, 2, v12
  v_lshl_or_b32 v89, v13, 10, v12
  v_lshl_or_b32 v109, v109, 5, s32
  v_lshlrev_b32 v15, 20, v14
  v_lshlrev_b32 v14, 1, v14
  v_and_or_b32 v109, v15, s37, v109
  v_and_or_b32 v109, v14, 30, v109
  ds_add_rtn_u32 v7, v89, v3 offset:0
  v_lshlrev_b32 v12, 16, v118
  v_and_b32 v13, s38, v118
  v_mul_f32 v12, s31, v12
  v_mul_f32 v13, s31, v13
  v_cvt_pk_bf16_f32 v14, v12, v13
  v_lshlrev_b32 v12, 16, v14
  v_and_b32 v13, s38, v14
  v_mul_f32 v14, s33, v12
  v_mul_f32 v15, s33, v13
  v_fract_f32 v14, v14
  v_fract_f32 v15, v15
  v_fma_f32 v14, v12, s34, v14
  v_fma_f32 v15, v13, s34, v15
  v_cos_f32 v14, v14
  v_cos_f32 v15, v15
  s_nop 0
  v_cvt_pk_bf16_f32 v118, v14, v15
  v_lshlrev_b32 v12, 16, v119
  v_and_b32 v13, s38, v119
  v_mul_f32 v12, s31, v12
  v_mul_f32 v13, s31, v13
  v_cvt_pk_bf16_f32 v14, v12, v13
  v_lshlrev_b32 v12, 16, v14
  v_and_b32 v13, s38, v14
  v_mul_f32 v14, s33, v12
  v_mul_f32 v15, s33, v13
  v_fract_f32 v14, v14
  v_fract_f32 v15, v15
  v_fma_f32 v14, v12, s34, v14
  v_fma_f32 v15, v13, s34, v15
  v_cos_f32 v14, v14
  v_cos_f32 v15, v15
  s_nop 0
  v_cvt_pk_bf16_f32 v119, v14, v15
  s_waitcnt lgkmcnt(4)
  v_lshl_or_b32 v82, v8, 12, v82
  v_lshl_or_b32 v83, v9, 12, v83
  v_lshl_or_b32 v84, v10, 12, v84
  v_lshl_or_b32 v85, v11, 12, v85
  s_waitcnt lgkmcnt(0)
  v_lshl_or_b32 v86, v4, 12, v86
  v_lshl_or_b32 v87, v5, 12, v87
  v_lshl_or_b32 v88, v6, 12, v88
  v_lshl_or_b32 v89, v7, 12, v89
  s_barrier
  ds_read_b32 v4, v16 offset:0
  s_waitcnt lgkmcnt(0)
  v_add_u32 v5, 1, v4
  v_and_b32 v5, -2, v5
  v_mov_b32 v6, v5
  s_nop 1
  v_add_u32_dpp v6, v6, v6 row_shr:1 row_mask:0xf bank_mask:0xf bound_ctrl:0
  s_nop 1
  v_add_u32_dpp v6, v6, v6 row_shr:2 row_mask:0xf bank_mask:0xf bound_ctrl:0
  s_nop 1
  v_add_u32_dpp v6, v6, v6 row_shr:4 row_mask:0xf bank_mask:0xf bound_ctrl:0
  s_nop 1
  v_add_u32_dpp v6, v6, v6 row_shr:8 row_mask:0xf bank_mask:0xf bound_ctrl:0
  s_nop 1
  v_add_u32_dpp v6, v6, v6 row_bcast:15 row_mask:0xa bank_mask:0xf
  s_nop 1
  v_add_u32_dpp v6, v6, v6 row_bcast:31 row_mask:0xc bank_mask:0xf
  s_nop 1
  v_readlane_b32 s43, v6, 63
  s_lshl_b32 s44, s35, 2
  v_mov_b32 v7, s44
  s_nop 0
  v_mov_b32 v8, s43
  ds_write_b32 v7, v8 offset:4096
  s_waitcnt lgkmcnt(0)
  s_barrier
  ds_read_b32 v7, v17 offset:4096
  s_waitcnt lgkmcnt(0)
  s_nop 1
  v_add_u32_dpp v7, v7, v7 row_shr:1 row_mask:0xf bank_mask:0xf bound_ctrl:0
  s_nop 1
  v_add_u32_dpp v7, v7, v7 row_shr:2 row_mask:0xf bank_mask:0xf bound_ctrl:0
  s_nop 1
  v_add_u32_dpp v7, v7, v7 row_shr:4 row_mask:0xf bank_mask:0xf bound_ctrl:0
  s_nop 1
  v_add_u32_dpp v7, v7, v7 row_shr:8 row_mask:0xf bank_mask:0xf bound_ctrl:0
  s_nop 1
  s_sub_u32 s44, s35, 1
  s_max_i32 s44, s44, 0
  v_readlane_b32 s43, v7, s44
  s_cmp_eq_u32 s35, 0
  s_cselect_b32 s43, 0, s43
  v_sub_u32 v6, v6, v5
  s_nop 1
  v_add_u32 v6, s43, v6
  ds_write_b32 v16, v6 offset:0
  v_add_u32 v7, v6, v5
  v_lshrrev_b32 v8, 1, v6
  v_lshrrev_b32 v7, 1, v7
  v_lshl_or_b32 v7, v7, 16, v8
  s_lshl_b32 s44, s36, 2
  buffer_store_dword v7, v18, s[24:27], s44 offen
  v_and_b32 v8, 1, v4
  v_cmp_eq_u32 vcc, 1, v8
  v_add_u32 v8, v6, v4
  v_mul_u32_u24 v8, 6, v8
  v_mov_b32 v9, 0
  s_and_saveexec_b64 s[46:47], vcc
  ds_write_b32 v8, v9 offset:4222
  s_mov_b64 exec, s[46:47]
  s_waitcnt lgkmcnt(0)
  s_barrier
  v_and_b32 v4, s39, v70
  ds_read_b32 v4, v4 offset:0
  v_and_b32 v5, s39, v71
  ds_read_b32 v5, v5 offset:0
  v_and_b32 v6, s39, v72
  ds_read_b32 v6, v6 offset:0
  v_and_b32 v7, s39, v73
  ds_read_b32 v7, v7 offset:0
  v_and_b32 v8, s39, v74
  ds_read_b32 v8, v8 offset:0
  v_and_b32 v9, s39, v75
  ds_read_b32 v9, v9 offset:0
  v_and_b32 v10, s39, v76
  ds_read_b32 v10, v10 offset:0
  v_and_b32 v11, s39, v77
  ds_read_b32 v11, v11 offset:0
  s_waitcnt lgkmcnt(4)
  v_lshrrev_b32 v12, 12, v70
  v_add_u32 v12, v12, v4
  v_and_b32 v13, 1, v12
  v_mul_u32_u24 v12, 6, v12
  v_mad_i32_i24 v12, v13, -2, v12
  v_mad_i32_i24 v13, v13, -2, v12
  ds_write_b32 v12, v90 offset:4224
  ds_write_b16 v13, v110 offset:4232
  v_lshrrev_b32 v12, 12, v71
  v_add_u32 v12, v12, v5
  v_and_b32 v13, 1, v12
  v_mul_u32_u24 v12, 6, v12
  v_mad_i32_i24 v12, v13, -2, v12
  v_mad_i32_i24 v13, v13, -2, v12
  ds_write_b32 v12, v91 offset:4224
  ds_write_b16_d16_hi v13, v110 offset:4232
  v_lshrrev_b32 v12, 12, v72
  v_add_u32 v12, v12, v6
  v_and_b32 v13, 1, v12
  v_mul_u32_u24 v12, 6, v12
  v_mad_i32_i24 v12, v13, -2, v12
  v_mad_i32_i24 v13, v13, -2, v12
  ds_write_b32 v12, v92 offset:4224
  ds_write_b16 v13, v111 offset:4232
  v_lshrrev_b32 v12, 12, v73
  v_add_u32 v12, v12, v7
  v_and_b32 v13, 1, v12
  v_mul_u32_u24 v12, 6, v12
  v_mad_i32_i24 v12, v13, -2, v12
  v_mad_i32_i24 v13, v13, -2, v12
  ds_write_b32 v12, v93 offset:4224
  ds_write_b16_d16_hi v13, v111 offset:4232
  v_and_b32 v4, s39, v78
  ds_read_b32 v4, v4 offset:0
  v_and_b32 v5, s39, v79
  ds_read_b32 v5, v5 offset:0
  v_and_b32 v6, s39, v80
  ds_read_b32 v6, v6 offset:0
  v_and_b32 v7, s39, v81
  ds_read_b32 v7, v7 offset:0
  s_waitcnt lgkmcnt(4)
  v_lshrrev_b32 v12, 12, v74
  v_add_u32 v12, v12, v8
  v_and_b32 v13, 1, v12
  v_mul_u32_u24 v12, 6, v12
  v_mad_i32_i24 v12, v13, -2, v12
  v_mad_i32_i24 v13, v13, -2, v12
  ds_write_b32 v12, v94 offset:4224
  ds_write_b16 v13, v112 offset:4232
  v_lshrrev_b32 v12, 12, v75
  v_add_u32 v12, v12, v9
  v_and_b32 v13, 1, v12
  v_mul_u32_u24 v12, 6, v12
  v_mad_i32_i24 v12, v13, -2, v12
  v_mad_i32_i24 v13, v13, -2, v12
  ds_write_b32 v12, v95 offset:4224
  ds_write_b16_d16_hi v13, v112 offset:4232
  v_lshrrev_b32 v12, 12, v76
  v_add_u32 v12, v12, v10
  v_and_b32 v13, 1, v12
  v_mul_u32_u24 v12, 6, v12
  v_mad_i32_i24 v12, v13, -2, v12
  v_mad_i32_i24 v13, v13, -2, v12
  ds_write_b32 v12, v96 offset:4224
  ds_write_b16 v13, v113 offset:4232
  v_lshrrev_b32 v12, 12, v77
  v_add_u32 v12, v12, v11
  v_and_b32 v13, 1, v12
  v_mul_u32_u24 v12, 6, v12
  v_mad_i32_i24 v12, v13, -2, v12
  v_mad_i32_i24 v13, v13, -2, v12
  ds_write_b32 v12, v97 offset:4224
  ds_write_b16_d16_hi v13, v113 offset:4232
  v_and_b32 v8, s39, v82
  ds_read_b32 v8, v8 offset:0
  v_and_b32 v9, s39, v83
  ds_read_b32 v9, v9 offset:0
  v_and_b32 v10, s39, v84
  ds_read_b32 v10, v10 offset:0
  v_and_b32 v11, s39, v85
  ds_read_b32 v11, v11 offset:0
  s_waitcnt lgkmcnt(4)
  v_lshrrev_b32 v12, 12, v78
  v_add_u32 v12, v12, v4
  v_and_b32 v13, 1, v12
  v_mul_u32_u24 v12, 6, v12
  v_mad_i32_i24 v12, v13, -2, v12
  v_mad_i32_i24 v13, v13, -2, v12
  ds_write_b32 v12, v98 offset:4224
  ds_write_b16 v13, v114 offset:4232
  v_lshrrev_b32 v12, 12, v79
  v_add_u32 v12, v12, v5
  v_and_b32 v13, 1, v12
  v_mul_u32_u24 v12, 6, v12
  v_mad_i32_i24 v12, v13, -2, v12
  v_mad_i32_i24 v13, v13, -2, v12
  ds_write_b32 v12, v99 offset:4224
  ds_write_b16_d16_hi v13, v114 offset:4232
  v_lshrrev_b32 v12, 12, v80
  v_add_u32 v12, v12, v6
  v_and_b32 v13, 1, v12
  v_mul_u32_u24 v12, 6, v12
  v_mad_i32_i24 v12, v13, -2, v12
  v_mad_i32_i24 v13, v13, -2, v12
  ds_write_b32 v12, v100 offset:4224
  ds_write_b16 v13, v115 offset:4232
  v_lshrrev_b32 v12, 12, v81
  v_add_u32 v12, v12, v7
  v_and_b32 v13, 1, v12
  v_mul_u32_u24 v12, 6, v12
  v_mad_i32_i24 v12, v13, -2, v12
  v_mad_i32_i24 v13, v13, -2, v12
  ds_write_b32 v12, v101 offset:4224
  ds_write_b16_d16_hi v13, v115 offset:4232
  v_and_b32 v4, s39, v86
  ds_read_b32 v4, v4 offset:0
  v_and_b32 v5, s39, v87
  ds_read_b32 v5, v5 offset:0
  v_and_b32 v6, s39, v88
  ds_read_b32 v6, v6 offset:0
  v_and_b32 v7, s39, v89
  ds_read_b32 v7, v7 offset:0
  s_waitcnt lgkmcnt(4)
  v_lshrrev_b32 v12, 12, v82
  v_add_u32 v12, v12, v8
  v_and_b32 v13, 1, v12
  v_mul_u32_u24 v12, 6, v12
  v_mad_i32_i24 v12, v13, -2, v12
  v_mad_i32_i24 v13, v13, -2, v12
  ds_write_b32 v12, v102 offset:4224
  ds_write_b16 v13, v116 offset:4232
  v_lshrrev_b32 v12, 12, v83
  v_add_u32 v12, v12, v9
  v_and_b32 v13, 1, v12
  v_mul_u32_u24 v12, 6, v12
  v_mad_i32_i24 v12, v13, -2, v12
  v_mad_i32_i24 v13, v13, -2, v12
  ds_write_b32 v12, v103 offset:4224
  ds_write_b16_d16_hi v13, v116 offset:4232
  v_lshrrev_b32 v12, 12, v84
  v_add_u32 v12, v12, v10
  v_and_b32 v13, 1, v12
  v_mul_u32_u24 v12, 6, v12
  v_mad_i32_i24 v12, v13, -2, v12
  v_mad_i32_i24 v13, v13, -2, v12
  ds_write_b32 v12, v104 offset:4224
  ds_write_b16 v13, v117 offset:4232
  v_lshrrev_b32 v12, 12, v85
  v_add_u32 v12, v12, v11
  v_and_b32 v13, 1, v12
  v_mul_u32_u24 v12, 6, v12
  v_mad_i32_i24 v12, v13, -2, v12
  v_mad_i32_i24 v13, v13, -2, v12
  ds_write_b32 v12, v105 offset:4224
  ds_write_b16_d16_hi v13, v117 offset:4232
  s_waitcnt lgkmcnt(0)
  v_lshrrev_b32 v12, 12, v86
  v_add_u32 v12, v12, v4
  v_and_b32 v13, 1, v12
  v_mul_u32_u24 v12, 6, v12
  v_mad_i32_i24 v12, v13, -2, v12
  v_mad_i32_i24 v13, v13, -2, v12
  ds_write_b32 v12, v106 offset:4224
  ds_write_b16 v13, v118 offset:4232
  v_lshrrev_b32 v12, 12, v87
  v_add_u32 v12, v12, v5
  v_and_b32 v13, 1, v12
  v_mul_u32_u24 v12, 6, v12
  v_mad_i32_i24 v12, v13, -2, v12
  v_mad_i32_i24 v13, v13, -2, v12
  ds_write_b32 v12, v107 offset:4224
  ds_write_b16_d16_hi v13, v118 offset:4232
  v_lshrrev_b32 v12, 12, v88
  v_add_u32 v12, v12, v6
  v_and_b32 v13, 1, v12
  v_mul_u32_u24 v12, 6, v12
  v_mad_i32_i24 v12, v13, -2, v12
  v_mad_i32_i24 v13, v13, -2, v12
  ds_write_b32 v12, v108 offset:4224
  ds_write_b16 v13, v119 offset:4232
  v_lshrrev_b32 v12, 12, v89
  v_add_u32 v12, v12, v7
  v_and_b32 v13, 1, v12
  v_mul_u32_u24 v12, 6, v12
  v_mad_i32_i24 v12, v13, -2, v12
  v_mad_i32_i24 v13, v13, -2, v12
  ds_write_b32 v12, v109 offset:4224
  ds_write_b16_d16_hi v13, v119 offset:4232
  s_waitcnt lgkmcnt(0)
  s_barrier
  v_mov_b32 v9, 0
  ds_write_b32 v16, v9 offset:0
  ds_read_b128 v[70:73], v1 offset:4224
  ds_read_b128 v[74:77], v1 offset:20608
  ds_read_b128 v[78:81], v1 offset:36992
  ds_read_b128 v[82:85], v19 offset:4224
  ds_read_b128 v[86:89], v19 offset:20608
  ds_read_b128 v[90:93], v19 offset:36992
  ds_read_b128 v[94:97], v19 offset:53376
  s_cmp_lt_u32 s35, 14
  s_cbranch_scc0 L_k1_skip7_b
  v_add_u32 v12, 65536, v19
  ds_read_b128 v[98:101], v12 offset:4224
L_k1_skip7_b:
  s_mul_i32 s44, s36, 129024
  s_waitcnt lgkmcnt(0)
  s_barrier
  buffer_store_dwordx4 v[70:73], v1, s[20:23], s44 offen sc0 sc1
  s_add_u32 s44, s44, 16384
  buffer_store_dwordx4 v[74:77], v1, s[20:23], s44 offen sc0 sc1
  s_add_u32 s44, s44, 16384
  buffer_store_dwordx4 v[78:81], v1, s[20:23], s44 offen sc0 sc1
  s_add_u32 s44, s44, 16384
  buffer_store_dwordx4 v[82:85], v1, s[20:23], s44 offen sc0 sc1
  s_add_u32 s44, s44, 16384
  buffer_store_dwordx4 v[86:89], v1, s[20:23], s44 offen sc0 sc1
  s_add_u32 s44, s44, 16384
  buffer_store_dwordx4 v[90:93], v1, s[20:23], s44 offen sc0 sc1
  s_add_u32 s44, s44, 16384
  buffer_store_dwordx4 v[94:97], v1, s[20:23], s44 offen sc0 sc1
  s_add_u32 s44, s44, 16384
  s_cmp_lt_u32 s35, 14
  s_cbranch_scc0 L_k1_skip7s_b
  buffer_store_dwordx4 v[98:101], v1, s[20:23], s44 offen sc0 sc1
L_k1_skip7s_b:
  s_waitcnt vmcnt(0)
L_k1_fin:
L_k1_end:
  s_endpgm
.p2align 8
.globl k2_kernel
.type k2_kernel,@function
k2_kernel:
  s_cmp_ge_u32 s2, 256
  s_cbranch_scc1 L_k2_end
  s_load_dwordx2 s[4:5], s[0:1], 0
  s_load_dwordx2 s[6:7], s[0:1], 104
  s_and_b32 s3, s2, 7
  s_lshl_b32 s3, s3, 5
  s_lshr_b32 s36, s2, 3
  s_add_u32 s3, s3, s36
  v_lshrrev_b32 v4, 6, v0
  v_and_b32 v1, 63, v0
  v_readfirstlane_b32 s35, v4
  s_waitcnt lgkmcnt(0)
  s_mov_b32 s8, s4
  s_mov_b32 s9, s5
  s_mov_b32 s10, 10240000
  s_mov_b32 s11, 0x20000
  s_mov_b32 s12, s6
  s_mov_b32 s13, s7
  s_mov_b32 s14, 64512000
  s_mov_b32 s15, 0x20000
  s_add_u32 s16, s6, 64512000
  s_addc_u32 s17, s7, 0
  s_mov_b32 s18, 2097152
  s_mov_b32 s19, 0x20000
  s_cmp_ge_u32 s35, 8
  s_cbranch_scc1 L_k2_iwave
  s_load_dwordx2 s[38:39], s[0:1], 72
  v_mov_b32 v8, 0
  v_mov_b32 v9, 0
  v_mov_b32 v10, 0
  v_mov_b32 v11, 0
  v_lshlrev_b32 v5, 4, v0
  v_add_u32 v6, 65536, v5
  ds_write_b128 v6, v[8:11] offset:61440
  v_add_u32 v6, 131072, v5
  ds_write_b128 v6, v[8:11] offset:4096
  ds_write_b128 v6, v[8:11] offset:12288
  ds_write_b128 v6, v[8:11] offset:20480
  v_cmp_gt_u32 vcc, 256, v0
  s_and_saveexec_b64 s[40:41], vcc
  ds_write_b128 v6, v[8:11] offset:28672
  s_mov_b64 exec, s[40:41]
  v_add_u32 v6, 0, v5
  ds_write_b128 v6, v[8:11] offset:0
  ds_write_b128 v6, v[8:11] offset:8192
  ds_write_b128 v6, v[8:11] offset:16384
  ds_write_b128 v6, v[8:11] offset:24576
  ds_write_b128 v6, v[8:11] offset:32768
  v_cmp_gt_u32 vcc, 80, v0
  s_and_saveexec_b64 s[40:41], vcc
  ds_write_b128 v6, v[8:11] offset:40960
  s_mov_b64 exec, s[40:41]
  v_mov_b32 v8, 0xffffe0
  v_mov_b32 v9, 0xffffe0
  v_mov_b32 v10, 0xffffe0
  v_mov_b32 v11, 0xffffe0
  v_add_u32 v6, 0, v5
  ds_write_b128 v6, v[8:11] offset:42240
  ds_write_b128 v6, v[8:11] offset:50432
  ds_write_b128 v6, v[8:11] offset:58624
  v_add_u32 v6, 65536, v5
  ds_write_b128 v6, v[8:11] offset:1280
  ds_write_b128 v6, v[8:11] offset:9472
  ds_write_b128 v6, v[8:11] offset:17664
  ds_write_b128 v6, v[8:11] offset:25856
  ds_write_b128 v6, v[8:11] offset:34048
  ds_write_b128 v6, v[8:11] offset:42240
  ds_write_b128 v6, v[8:11] offset:50432
  v_cmp_gt_u32 vcc, 160, v0
  s_and_saveexec_b64 s[40:41], vcc
  ds_write_b128 v6, v[8:11] offset:58624
  s_mov_b64 exec, s[40:41]
  s_waitcnt lgkmcnt(0)
  v_lshrrev_b32 v2, 1, v1
  v_lshlrev_b32 v2, 2, v2
  v_and_b32 v3, 1, v1
  v_lshlrev_b32 v3, 4, v3
  s_mul_i32 s82, s35, 3072
  s_add_u32 s82, s82, 139264
  s_add_u32 s83, s82, 1024
  s_add_u32 s84, s82, 2048
  v_lshl_add_u32 v17, v1, 3, s82
  v_lshlrev_b32 v16, 4, v1
  v_mul_u32_u24 v14, 528, v1
  s_mov_b32 s44, 0xffffe0
  s_lshl_b32 s40, s35, 10
  s_add_u32 s40, s40, 126976
  v_lshrrev_b32 v20, 1, v1
  v_lshl_add_u32 v4, v20, 5, s40
  v_lshl_add_u32 v5, v1, 3, s40
  s_mov_b32 s28, s38
  s_mov_b32 s29, s39
  s_mov_b32 s30, 512
  s_mov_b32 s31, 0x20000
  v_lshrrev_b32 v19, 4, v1
  v_and_b32 v18, 15, v1
  v_lshrrev_b32 v20, 1, v19
  v_lshlrev_b32 v20, 8, v20
  v_lshl_add_u32 v20, v18, 1, v20
  buffer_load_ushort v26, v20, s[28:31], 0 offen offset:0
  buffer_load_ushort v27, v20, s[28:31], 0 offen offset:32
  buffer_load_ushort v28, v20, s[28:31], 0 offen offset:64
  buffer_load_ushort v29, v20, s[28:31], 0 offen offset:96
  buffer_load_ushort v30, v20, s[28:31], 0 offen offset:128
  buffer_load_ushort v31, v20, s[28:31], 0 offen offset:160
  buffer_load_ushort v32, v20, s[28:31], 0 offen offset:192
  buffer_load_ushort v33, v20, s[28:31], 0 offen offset:224
  v_mov_b32 v6, 0
  v_mov_b32 v12, 138240
  v_mov_b32 v13, 1
  v_mov_b32 v11, v4
  v_and_b32 v21, 1, v19
  v_cmp_eq_u32 s[40:41], 0, v21
  v_mov_b32 v38, 0
  v_mov_b32 v39, 0
  v_mov_b32 v40, 0
  v_mov_b32 v41, 0
  v_mov_b32 v50, 0xffffe0
  v_mov_b32 v53, 0
  v_mov_b32 v42, 0
  v_mov_b32 v43, 0
  v_mov_b32 v44, 0
  v_mov_b32 v45, 0
  v_mov_b32 v51, 0xffffe0
  v_mov_b32 v54, 0
  v_mov_b32 v46, 0
  v_mov_b32 v47, 0
  v_mov_b32 v48, 0
  v_mov_b32 v49, 0
  v_mov_b32 v52, 0xffffe0
  v_mov_b32 v55, 0
  v_mov_b32 v56, 0
  v_mov_b32 v57, 0
  v_mov_b32 v58, 0
  v_mov_b32 v59, 0
  v_mov_b32 v60, 0
  v_mov_b32 v61, 0
  v_mov_b32 v62, 0
  v_mov_b32 v63, 0
  v_mov_b32 v64, 0
  v_mov_b32 v65, 0
  v_mov_b32 v66, 0
  v_mov_b32 v67, 0
  v_mov_b32 v88, 0
  v_mov_b32 v89, 0
  v_mov_b32 v90, 0
  v_mov_b32 v91, 0
  v_mov_b32 v92, 0
  v_mov_b32 v93, 0
  v_mov_b32 v94, 0
  v_mov_b32 v95, 0
  v_mov_b32 v96, 0
  v_mov_b32 v97, 0
  v_mov_b32 v98, 0
  v_mov_b32 v99, 0
  v_mov_b32 v100, 0
  v_mov_b32 v101, 0
  v_mov_b32 v102, 0
  v_mov_b32 v103, 0
  v_mov_b32 v104, 0
  v_mov_b32 v105, 0
  v_mov_b32 v106, 0
  v_mov_b32 v107, 0
  v_mov_b32 v108, 0
  v_mov_b32 v109, 0
  v_mov_b32 v110, 0
  v_mov_b32 v111, 0
  v_mov_b32 v112, 0
  v_mov_b32 v113, 0
  v_mov_b32 v114, 0
  v_mov_b32 v115, 0
  v_mov_b32 v116, 0
  v_mov_b32 v117, 0
  v_mov_b32 v118, 0
  v_mov_b32 v119, 0
  v_mov_b32 v120, 0
  v_mov_b32 v121, 0
  v_mov_b32 v122, 0
  v_mov_b32 v123, 0
  v_mov_b32 v124, 0
  v_mov_b32 v125, 0
  v_mov_b32 v126, 0
  v_mov_b32 v127, 0
  s_waitcnt vmcnt(0)
  v_lshl_or_b32 v26, v27, 16, v26
  v_lshl_or_b32 v27, v29, 16, v28
  v_lshl_or_b32 v28, v31, 16, v30
  v_lshl_or_b32 v29, v33, 16, v32
  v_cndmask_b32 v18, v6, v26, s[40:41]
  v_cndmask_b32 v22, v26, v6, s[40:41]
  v_cndmask_b32 v19, v6, v27, s[40:41]
  v_cndmask_b32 v23, v27, v6, s[40:41]
  v_cndmask_b32 v20, v6, v28, s[40:41]
  v_cndmask_b32 v24, v28, v6, s[40:41]
  v_cndmask_b32 v21, v6, v29, s[40:41]
  v_cndmask_b32 v25, v29, v6, s[40:41]
  s_barrier
  s_setprio 1
  s_mov_b32 s59, -1
  s_mov_b32 s60, 0
  s_mov_b32 s61, 8
  s_call_b64 s[30:31], L_setup
  s_mov_b64 s[48:49], s[64:65]
  s_mov_b64 s[50:51], s[66:67]
  s_mov_b64 s[52:53], s[68:69]
  s_mov_b64 s[54:55], s[70:71]
  s_mov_b64 s[56:57], s[72:73]
  s_add_u32 s47, s48, 3
L_g_0_0:
  s_waitcnt lgkmcnt(6)
  s_mov_b32 m0, s84
  v_and_or_b32 v8, v52, s44, v3
  buffer_load_dwordx4 v8, s[8:11], 0 offen lds
  s_waitcnt vmcnt(2)
  ds_read_b64_tr_b16 v[26:27], v17 offset:0
  ds_read_b64_tr_b16 v[28:29], v17 offset:512
  v_readlane_b32 s46, v7, s45
  s_add_u32 s45, s45, 1
  v_and_or_b32 v10, v52, 30, v4
  v_add_u32 v9, s46, v2
  ds_write_b16 v11, v6
  ds_write_b16 v10, v55
  v_mov_b32 v11, v10
  ds_read_b64_tr_b16 v[64:65], v5
  ds_read_b64_tr_b16 v[66:67], v5 offset:512
  ds_read_b32 v51, v9 offset:42240
  v_lshrrev_b32 v9, 1, v9
  ds_read_u16 v54, v9
  s_cmp_eq_u32 s45, s58
  s_cbranch_scc1 L_gc_0_0
L_gb_0_0:
  s_sub_u32 s47, s47, 1
  s_waitcnt lgkmcnt(6)
  v_mfma_f32_16x16x32_bf16 v[88:91], v[26:29], v[56:59], v[88:91]
  s_cbranch_scc1 L_gn_1_1
L_g_0_1:
  s_waitcnt lgkmcnt(6)
  s_mov_b32 m0, s82
  v_and_or_b32 v8, v50, s44, v3
  buffer_load_dwordx4 v8, s[8:11], 0 offen lds
  s_waitcnt vmcnt(2)
  ds_read_b64_tr_b16 v[26:27], v17 offset:1024
  ds_read_b64_tr_b16 v[28:29], v17 offset:1536
  v_readlane_b32 s46, v7, s45
  s_add_u32 s45, s45, 1
  v_and_or_b32 v10, v50, 30, v4
  v_add_u32 v9, s46, v2
  ds_write_b16 v11, v6
  ds_write_b16 v10, v53
  v_mov_b32 v11, v10
  ds_read_b64_tr_b16 v[56:57], v5
  ds_read_b64_tr_b16 v[58:59], v5 offset:512
  ds_read_b32 v52, v9 offset:42240
  v_lshrrev_b32 v9, 1, v9
  ds_read_u16 v55, v9
  s_cmp_eq_u32 s45, s58
  s_cbranch_scc1 L_gc_0_1
L_gb_0_1:
  s_sub_u32 s47, s47, 1
  s_waitcnt lgkmcnt(6)
  v_mfma_f32_16x16x32_bf16 v[88:91], v[26:29], v[60:63], v[88:91]
  s_cbranch_scc1 L_gn_1_2
L_g_0_2:
  s_waitcnt lgkmcnt(6)
  s_mov_b32 m0, s83
  v_and_or_b32 v8, v51, s44, v3
  buffer_load_dwordx4 v8, s[8:11], 0 offen lds
  s_waitcnt vmcnt(2)
  ds_read_b64_tr_b16 v[26:27], v17 offset:2048
  ds_read_b64_tr_b16 v[28:29], v17 offset:2560
  v_readlane_b32 s46, v7, s45
  s_add_u32 s45, s45, 1
  v_and_or_b32 v10, v51, 30, v4
  v_add_u32 v9, s46, v2
  ds_write_b16 v11, v6
  ds_write_b16 v10, v54
  v_mov_b32 v11, v10
  ds_read_b64_tr_b16 v[60:61], v5
  ds_read_b64_tr_b16 v[62:63], v5 offset:512
  ds_read_b32 v50, v9 offset:42240
  v_lshrrev_b32 v9, 1, v9
  ds_read_u16 v53, v9
  s_cmp_eq_u32 s45, s58
  s_cbranch_scc1 L_gc_0_2
L_gb_0_2:
  s_sub_u32 s47, s47, 1
  s_waitcnt lgkmcnt(6)
  v_mfma_f32_16x16x32_bf16 v[88:91], v[26:29], v[64:67], v[88:91]
  s_cbranch_scc1 L_gn_1_0
  s_branch L_g_0_0
L_g_1_0:
  s_waitcnt lgkmcnt(6)
  s_mov_b32 m0, s84
  v_and_or_b32 v8, v52, s44, v3
  buffer_load_dwordx4 v8, s[8:11], 0 offen lds
  s_waitcnt vmcnt(2)
  ds_read_b64_tr_b16 v[26:27], v17 offset:0
  ds_read_b64_tr_b16 v[28:29], v17 offset:512
  v_readlane_b32 s46, v7, s45
  s_add_u32 s45, s45, 1
  v_and_or_b32 v10, v52, 30, v4
  v_add_u32 v9, s46, v2
  ds_write_b16 v11, v6
  ds_write_b16 v10, v55
  v_mov_b32 v11, v10
  ds_read_b64_tr_b16 v[64:65], v5
  ds_read_b64_tr_b16 v[66:67], v5 offset:512
  ds_read_b32 v51, v9 offset:42240
  v_lshrrev_b32 v9, 1, v9
  ds_read_u16 v54, v9
  s_cmp_eq_u32 s45, s58
  s_cbranch_scc1 L_gc_1_0
L_gb_1_0:
  s_sub_u32 s47, s47, 1
  s_waitcnt lgkmcnt(6)
  v_mfma_f32_16x16x32_bf16 v[92:95], v[26:29], v[56:59], v[92:95]
  s_cbranch_scc1 L_gn_2_1
L_g_1_1:
  s_waitcnt lgkmcnt(6)
  s_mov_b32 m0, s82
  v_and_or_b32 v8, v50, s44, v3
  buffer_load_dwordx4 v8, s[8:11], 0 offen lds
  s_waitcnt vmcnt(2)
  ds_read_b64_tr_b16 v[26:27], v17 offset:1024
  ds_read_b64_tr_b16 v[28:29], v17 offset:1536
  v_readlane_b32 s46, v7, s45
  s_add_u32 s45, s45, 1
  v_and_or_b32 v10, v50, 30, v4
  v_add_u32 v9, s46, v2
  ds_write_b16 v11, v6
  ds_write_b16 v10, v53
  v_mov_b32 v11, v10
  ds_read_b64_tr_b16 v[56:57], v5
  ds_read_b64_tr_b16 v[58:59], v5 offset:512
  ds_read_b32 v52, v9 offset:42240
  v_lshrrev_b32 v9, 1, v9
  ds_read_u16 v55, v9
  s_cmp_eq_u32 s45, s58
  s_cbranch_scc1 L_gc_1_1
L_gb_1_1:
  s_sub_u32 s47, s47, 1
  s_waitcnt lgkmcnt(6)
  v_mfma_f32_16x16x32_bf16 v[92:95], v[26:29], v[60:63], v[92:95]
  s_cbranch_scc1 L_gn_2_2
L_g_1_2:
  s_waitcnt lgkmcnt(6)
  s_mov_b32 m0, s83
  v_and_or_b32 v8, v51, s44, v3
  buffer_load_dwordx4 v8, s[8:11], 0 offen lds
  s_waitcnt vmcnt(2)
  ds_read_b64_tr_b16 v[26:27], v17 offset:2048
  ds_read_b64_tr_b16 v[28:29], v17 offset:2560
  v_readlane_b32 s46, v7, s45
  s_add_u32 s45, s45, 1
  v_and_or_b32 v10, v51, 30, v4
  v_add_u32 v9, s46, v2
  ds_write_b16 v11, v6
  ds_write_b16 v10, v54
  v_mov_b32 v11, v10
  ds_read_b64_tr_b16 v[60:61], v5
  ds_read_b64_tr_b16 v[62:63], v5 offset:512
  ds_read_b32 v50, v9 offset:42240
  v_lshrrev_b32 v9, 1, v9
  ds_read_u16 v53, v9
  s_cmp_eq_u32 s45, s58
  s_cbranch_scc1 L_gc_1_2
L_gb_1_2:
  s_sub_u32 s47, s47, 1
  s_waitcnt lgkmcnt(6)
  v_mfma_f32_16x16x32_bf16 v[92:95], v[26:29], v[64:67], v[92:95]
  s_cbranch_scc1 L_gn_2_0
  s_branch L_g_1_0
L_g_2_0:
  s_waitcnt lgkmcnt(6)
  s_mov_b32 m0, s84
  v_and_or_b32 v8, v52, s44, v3
  buffer_load_dwordx4 v8, s[8:11], 0 offen lds
  s_waitcnt vmcnt(2)
  ds_read_b64_tr_b16 v[26:27], v17 offset:0
  ds_read_b64_tr_b16 v[28:29], v17 offset:512
  v_readlane_b32 s46, v7, s45
  s_add_u32 s45, s45, 1
  v_and_or_b32 v10, v52, 30, v4
  v_add_u32 v9, s46, v2
  ds_write_b16 v11, v6
  ds_write_b16 v10, v55
  v_mov_b32 v11, v10
  ds_read_b64_tr_b16 v[64:65], v5
  ds_read_b64_tr_b16 v[66:67], v5 offset:512
  ds_read_b32 v51, v9 offset:42240
  v_lshrrev_b32 v9, 1, v9
  ds_read_u16 v54, v9
  s_cmp_eq_u32 s45, s58
  s_cbranch_scc1 L_gc_2_0
L_gb_2_0:
  s_sub_u32 s47, s47, 1
  s_waitcnt lgkmcnt(6)
  v_mfma_f32_16x16x32_bf16 v[96:99], v[26:29], v[56:59], v[96:99]
  s_cbranch_scc1 L_gn_3_1
L_g_2_1:
  s_waitcnt lgkmcnt(6)
  s_mov_b32 m0, s82
  v_and_or_b32 v8, v50, s44, v3
  buffer_load_dwordx4 v8, s[8:11], 0 offen lds
  s_waitcnt vmcnt(2)
  ds_read_b64_tr_b16 v[26:27], v17 offset:1024
  ds_read_b64_tr_b16 v[28:29], v17 offset:1536
  v_readlane_b32 s46, v7, s45
  s_add_u32 s45, s45, 1
  v_and_or_b32 v10, v50, 30, v4
  v_add_u32 v9, s46, v2
  ds_write_b16 v11, v6
  ds_write_b16 v10, v53
  v_mov_b32 v11, v10
  ds_read_b64_tr_b16 v[56:57], v5
  ds_read_b64_tr_b16 v[58:59], v5 offset:512
  ds_read_b32 v52, v9 offset:42240
  v_lshrrev_b32 v9, 1, v9
  ds_read_u16 v55, v9
  s_cmp_eq_u32 s45, s58
  s_cbranch_scc1 L_gc_2_1
L_gb_2_1:
  s_sub_u32 s47, s47, 1
  s_waitcnt lgkmcnt(6)
  v_mfma_f32_16x16x32_bf16 v[96:99], v[26:29], v[60:63], v[96:99]
  s_cbranch_scc1 L_gn_3_2
L_g_2_2:
  s_waitcnt lgkmcnt(6)
  s_mov_b32 m0, s83
  v_and_or_b32 v8, v51, s44, v3
  buffer_load_dwordx4 v8, s[8:11], 0 offen lds
  s_waitcnt vmcnt(2)
  ds_read_b64_tr_b16 v[26:27], v17 offset:2048
  ds_read_b64_tr_b16 v[28:29], v17 offset:2560
  v_readlane_b32 s46, v7, s45
  s_add_u32 s45, s45, 1
  v_and_or_b32 v10, v51, 30, v4
  v_add_u32 v9, s46, v2
  ds_write_b16 v11, v6
  ds_write_b16 v10, v54
  v_mov_b32 v11, v10
  ds_read_b64_tr_b16 v[60:61], v5
  ds_read_b64_tr_b16 v[62:63], v5 offset:512
  ds_read_b32 v50, v9 offset:42240
  v_lshrrev_b32 v9, 1, v9
  ds_read_u16 v53, v9
  s_cmp_eq_u32 s45, s58
  s_cbranch_scc1 L_gc_2_2
L_gb_2_2:
  s_sub_u32 s47, s47, 1
  s_waitcnt lgkmcnt(6)
  v_mfma_f32_16x16x32_bf16 v[96:99], v[26:29], v[64:67], v[96:99]
  s_cbranch_scc1 L_gn_3_0
  s_branch L_g_2_0
L_g_3_0:
  s_waitcnt lgkmcnt(6)
  s_mov_b32 m0, s84
  v_and_or_b32 v8, v52, s44, v3
  buffer_load_dwordx4 v8, s[8:11], 0 offen lds
  s_waitcnt vmcnt(2)
  ds_read_b64_tr_b16 v[26:27], v17 offset:0
  ds_read_b64_tr_b16 v[28:29], v17 offset:512
  v_readlane_b32 s46, v7, s45
  s_add_u32 s45, s45, 1
  v_and_or_b32 v10, v52, 30, v4
  v_add_u32 v9, s46, v2
  ds_write_b16 v11, v6
  ds_write_b16 v10, v55
  v_mov_b32 v11, v10
  ds_read_b64_tr_b16 v[64:65], v5
  ds_read_b64_tr_b16 v[66:67], v5 offset:512
  ds_read_b32 v51, v9 offset:42240
  v_lshrrev_b32 v9, 1, v9
  ds_read_u16 v54, v9
  s_cmp_eq_u32 s45, s58
  s_cbranch_scc1 L_gc_3_0
L_gb_3_0:
  s_sub_u32 s47, s47, 1
  s_waitcnt lgkmcnt(6)
  v_mfma_f32_16x16x32_bf16 v[100:103], v[26:29], v[56:59], v[100:103]
  s_cbranch_scc1 L_gn_4_1
L_g_3_1:
  s_waitcnt lgkmcnt(6)
  s_mov_b32 m0, s82
  v_and_or_b32 v8, v50, s44, v3
  buffer_load_dwordx4 v8, s[8:11], 0 offen lds
  s_waitcnt vmcnt(2)
  ds_read_b64_tr_b16 v[26:27], v17 offset:1024
  ds_read_b64_tr_b16 v[28:29], v17 offset:1536
  v_readlane_b32 s46, v7, s45
  s_add_u32 s45, s45, 1
  v_and_or_b32 v10, v50, 30, v4
  v_add_u32 v9, s46, v2
  ds_write_b16 v11, v6
  ds_write_b16 v10, v53
  v_mov_b32 v11, v10
  ds_read_b64_tr_b16 v[56:57], v5
  ds_read_b64_tr_b16 v[58:59], v5 offset:512
  ds_read_b32 v52, v9 offset:42240
  v_lshrrev_b32 v9, 1, v9
  ds_read_u16 v55, v9
  s_cmp_eq_u32 s45, s58
  s_cbranch_scc1 L_gc_3_1
L_gb_3_1:
  s_sub_u32 s47, s47, 1
  s_waitcnt lgkmcnt(6)
  v_mfma_f32_16x16x32_bf16 v[100:103], v[26:29], v[60:63], v[100:103]
  s_cbranch_scc1 L_gn_4_2
L_g_3_2:
  s_waitcnt lgkmcnt(6)
  s_mov_b32 m0, s83
  v_and_or_b32 v8, v51, s44, v3
  buffer_load_dwordx4 v8, s[8:11], 0 offen lds
  s_waitcnt vmcnt(2)
  ds_read_b64_tr_b16 v[26:27], v17 offset:2048
  ds_read_b64_tr_b16 v[28:29], v17 offset:2560
  v_readlane_b32 s46, v7, s45
  s_add_u32 s45, s45, 1
  v_and_or_b32 v10, v51, 30, v4
  v_add_u32 v9, s46, v2
  ds_write_b16 v11, v6
  ds_write_b16 v10, v54
  v_mov_b32 v11, v10
  ds_read_b64_tr_b16 v[60:61], v5
  ds_read_b64_tr_b16 v[62:63], v5 offset:512
  ds_read_b32 v50, v9 offset:42240
  v_lshrrev_b32 v9, 1, v9
  ds_read_u16 v53, v9
  s_cmp_eq_u32 s45, s58
  s_cbranch_scc1 L_gc_3_2
L_gb_3_2:
  s_sub_u32 s47, s47, 1
  s_waitcnt lgkmcnt(6)
  v_mfma_f32_16x16x32_bf16 v[100:103], v[26:29], v[64:67], v[100:103]
  s_cbranch_scc1 L_gn_4_0
  s_branch L_g_3_0
L_g_4_0:
  s_waitcnt lgkmcnt(6)
  s_mov_b32 m0, s84
  v_and_or_b32 v8, v52, s44, v3
  buffer_load_dwordx4 v8, s[8:11], 0 offen lds
  s_waitcnt vmcnt(2)
  ds_read_b64_tr_b16 v[26:27], v17 offset:0
  ds_read_b64_tr_b16 v[28:29], v17 offset:512
  v_readlane_b32 s46, v7, s45
  s_add_u32 s45, s45, 1
  v_and_or_b32 v10, v52, 30, v4
  v_add_u32 v9, s46, v2
  ds_write_b16 v11, v6
  ds_write_b16 v10, v55
  v_mov_b32 v11, v10
  ds_read_b64_tr_b16 v[64:65], v5
  ds_read_b64_tr_b16 v[66:67], v5 offset:512
  ds_read_b32 v51, v9 offset:42240
  v_lshrrev_b32 v9, 1, v9
  ds_read_u16 v54, v9
  s_cmp_eq_u32 s45, s58
  s_cbranch_scc1 L_gc_4_0
L_gb_4_0:
  s_sub_u32 s47, s47, 1
  s_waitcnt lgkmcnt(6)
  v_mfma_f32_16x16x32_bf16 v[104:107], v[26:29], v[56:59], v[104:107]
  s_cbranch_scc1 L_gn_5_1
L_g_4_1:
  s_waitcnt lgkmcnt(6)
  s_mov_b32 m0, s82
  v_and_or_b32 v8, v50, s44, v3
  buffer_load_dwordx4 v8, s[8:11], 0 offen lds
  s_waitcnt vmcnt(2)
  ds_read_b64_tr_b16 v[26:27], v17 offset:1024
  ds_read_b64_tr_b16 v[28:29], v17 offset:1536
  v_readlane_b32 s46, v7, s45
  s_add_u32 s45, s45, 1
  v_and_or_b32 v10, v50, 30, v4
  v_add_u32 v9, s46, v2
  ds_write_b16 v11, v6
  ds_write_b16 v10, v53
  v_mov_b32 v11, v10
  ds_read_b64_tr_b16 v[56:57], v5
  ds_read_b64_tr_b16 v[58:59], v5 offset:512
  ds_read_b32 v52, v9 offset:42240
  v_lshrrev_b32 v9, 1, v9
  ds_read_u16 v55, v9
  s_cmp_eq_u32 s45, s58
  s_cbranch_scc1 L_gc_4_1
L_gb_4_1:
  s_sub_u32 s47, s47, 1
  s_waitcnt lgkmcnt(6)
  v_mfma_f32_16x16x32_bf16 v[104:107], v[26:29], v[60:63], v[104:107]
  s_cbranch_scc1 L_gn_5_2
L_g_4_2:
  s_waitcnt lgkmcnt(6)
  s_mov_b32 m0, s83
  v_and_or_b32 v8, v51, s44, v3
  buffer_load_dwordx4 v8, s[8:11], 0 offen lds
  s_waitcnt vmcnt(2)
  ds_read_b64_tr_b16 v[26:27], v17 offset:2048
  ds_read_b64_tr_b16 v[28:29], v17 offset:2560
  v_readlane_b32 s46, v7, s45
  s_add_u32 s45, s45, 1
  v_and_or_b32 v10, v51, 30, v4
  v_add_u32 v9, s46, v2
  ds_write_b16 v11, v6
  ds_write_b16 v10, v54
  v_mov_b32 v11, v10
  ds_read_b64_tr_b16 v[60:61], v5
  ds_read_b64_tr_b16 v[62:63], v5 offset:512
  ds_read_b32 v50, v9 offset:42240
  v_lshrrev_b32 v9, 1, v9
  ds_read_u16 v53, v9
  s_cmp_eq_u32 s45, s58
  s_cbranch_scc1 L_gc_4_2
L_gb_4_2:
  s_sub_u32 s47, s47, 1
  s_waitcnt lgkmcnt(6)
  v_mfma_f32_16x16x32_bf16 v[104:107], v[26:29], v[64:67], v[104:107]
  s_cbranch_scc1 L_gn_5_0
  s_branch L_g_4_0
L_g_5_0:
  s_waitcnt lgkmcnt(6)
  s_mov_b32 m0, s84
  v_and_or_b32 v8, v52, s44, v3
  buffer_load_dwordx4 v8, s[8:11], 0 offen lds
  s_waitcnt vmcnt(2)
  ds_read_b64_tr_b16 v[26:27], v17 offset:0
  ds_read_b64_tr_b16 v[28:29], v17 offset:512
  v_readlane_b32 s46, v7, s45
  s_add_u32 s45, s45, 1
  v_and_or_b32 v10, v52, 30, v4
  v_add_u32 v9, s46, v2
  ds_write_b16 v11, v6
  ds_write_b16 v10, v55
  v_mov_b32 v11, v10
  ds_read_b64_tr_b16 v[64:65], v5
  ds_read_b64_tr_b16 v[66:67], v5 offset:512
  ds_read_b32 v51, v9 offset:42240
  v_lshrrev_b32 v9, 1, v9
  ds_read_u16 v54, v9
  s_cmp_eq_u32 s45, s58
  s_cbranch_scc1 L_gc_5_0
L_gb_5_0:
  s_sub_u32 s47, s47, 1
  s_waitcnt lgkmcnt(6)
  v_mfma_f32_16x16x32_bf16 v[108:111], v[26:29], v[56:59], v[108:111]
  s_cbranch_scc1 L_gn_6_1
L_g_5_1:
  s_waitcnt lgkmcnt(6)
  s_mov_b32 m0, s82
  v_and_or_b32 v8, v50, s44, v3
  buffer_load_dwordx4 v8, s[8:11], 0 offen lds
  s_waitcnt vmcnt(2)
  ds_read_b64_tr_b16 v[26:27], v17 offset:1024
  ds_read_b64_tr_b16 v[28:29], v17 offset:1536
  v_readlane_b32 s46, v7, s45
  s_add_u32 s45, s45, 1
  v_and_or_b32 v10, v50, 30, v4
  v_add_u32 v9, s46, v2
  ds_write_b16 v11, v6
  ds_write_b16 v10, v53
  v_mov_b32 v11, v10
  ds_read_b64_tr_b16 v[56:57], v5
  ds_read_b64_tr_b16 v[58:59], v5 offset:512
  ds_read_b32 v52, v9 offset:42240
  v_lshrrev_b32 v9, 1, v9
  ds_read_u16 v55, v9
  s_cmp_eq_u32 s45, s58
  s_cbranch_scc1 L_gc_5_1
L_gb_5_1:
  s_sub_u32 s47, s47, 1
  s_waitcnt lgkmcnt(6)
  v_mfma_f32_16x16x32_bf16 v[108:111], v[26:29], v[60:63], v[108:111]
  s_cbranch_scc1 L_gn_6_2
L_g_5_2:
  s_waitcnt lgkmcnt(6)
  s_mov_b32 m0, s83
  v_and_or_b32 v8, v51, s44, v3
  buffer_load_dwordx4 v8, s[8:11], 0 offen lds
  s_waitcnt vmcnt(2)
  ds_read_b64_tr_b16 v[26:27], v17 offset:2048
  ds_read_b64_tr_b16 v[28:29], v17 offset:2560
  v_readlane_b32 s46, v7, s45
  s_add_u32 s45, s45, 1
  v_and_or_b32 v10, v51, 30, v4
  v_add_u32 v9, s46, v2
  ds_write_b16 v11, v6
  ds_write_b16 v10, v54
  v_mov_b32 v11, v10
  ds_read_b64_tr_b16 v[60:61], v5
  ds_read_b64_tr_b16 v[62:63], v5 offset:512
  ds_read_b32 v50, v9 offset:42240
  v_lshrrev_b32 v9, 1, v9
  ds_read_u16 v53, v9
  s_cmp_eq_u32 s45, s58
  s_cbranch_scc1 L_gc_5_2
L_gb_5_2:
  s_sub_u32 s47, s47, 1
  s_waitcnt lgkmcnt(6)
  v_mfma_f32_16x16x32_bf16 v[108:111], v[26:29], v[64:67], v[108:111]
  s_cbranch_scc1 L_gn_6_0
  s_branch L_g_5_0
L_g_6_0:
  s_waitcnt lgkmcnt(6)
  s_mov_b32 m0, s84
  v_and_or_b32 v8, v52, s44, v3
  buffer_load_dwordx4 v8, s[8:11], 0 offen lds
  s_waitcnt vmcnt(2)
  ds_read_b64_tr_b16 v[26:27], v17 offset:0
  ds_read_b64_tr_b16 v[28:29], v17 offset:512
  v_readlane_b32 s46, v7, s45
  s_add_u32 s45, s45, 1
  v_and_or_b32 v10, v52, 30, v4
  v_add_u32 v9, s46, v2
  ds_write_b16 v11, v6
  ds_write_b16 v10, v55
  v_mov_b32 v11, v10
  ds_read_b64_tr_b16 v[64:65], v5
  ds_read_b64_tr_b16 v[66:67], v5 offset:512
  ds_read_b32 v51, v9 offset:42240
  v_lshrrev_b32 v9, 1, v9
  ds_read_u16 v54, v9
  s_cmp_eq_u32 s45, s58
  s_cbranch_scc1 L_gc_6_0
L_gb_6_0:
  s_sub_u32 s47, s47, 1
  s_waitcnt lgkmcnt(6)
  v_mfma_f32_16x16x32_bf16 v[112:115], v[26:29], v[56:59], v[112:115]
  s_cbranch_scc1 L_gn_7_1
L_g_6_1:
  s_waitcnt lgkmcnt(6)
  s_mov_b32 m0, s82
  v_and_or_b32 v8, v50, s44, v3
  buffer_load_dwordx4 v8, s[8:11], 0 offen lds
  s_waitcnt vmcnt(2)
  ds_read_b64_tr_b16 v[26:27], v17 offset:1024
  ds_read_b64_tr_b16 v[28:29], v17 offset:1536
  v_readlane_b32 s46, v7, s45
  s_add_u32 s45, s45, 1
  v_and_or_b32 v10, v50, 30, v4
  v_add_u32 v9, s46, v2
  ds_write_b16 v11, v6
  ds_write_b16 v10, v53
  v_mov_b32 v11, v10
  ds_read_b64_tr_b16 v[56:57], v5
  ds_read_b64_tr_b16 v[58:59], v5 offset:512
  ds_read_b32 v52, v9 offset:42240
  v_lshrrev_b32 v9, 1, v9
  ds_read_u16 v55, v9
  s_cmp_eq_u32 s45, s58
  s_cbranch_scc1 L_gc_6_1
L_gb_6_1:
  s_sub_u32 s47, s47, 1
  s_waitcnt lgkmcnt(6)
  v_mfma_f32_16x16x32_bf16 v[112:115], v[26:29], v[60:63], v[112:115]
  s_cbranch_scc1 L_gn_7_2
L_g_6_2:
  s_waitcnt lgkmcnt(6)
  s_mov_b32 m0, s83
  v_and_or_b32 v8, v51, s44, v3
  buffer_load_dwordx4 v8, s[8:11], 0 offen lds
  s_waitcnt vmcnt(2)
  ds_read_b64_tr_b16 v[26:27], v17 offset:2048
  ds_read_b64_tr_b16 v[28:29], v17 offset:2560
  v_readlane_b32 s46, v7, s45
  s_add_u32 s45, s45, 1
  v_and_or_b32 v10, v51, 30, v4
  v_add_u32 v9, s46, v2
  ds_write_b16 v11, v6
  ds_write_b16 v10, v54
  v_mov_b32 v11, v10
  ds_read_b64_tr_b16 v[60:61], v5
  ds_read_b64_tr_b16 v[62:63], v5 offset:512
  ds_read_b32 v50, v9 offset:42240
  v_lshrrev_b32 v9, 1, v9
  ds_read_u16 v53, v9
  s_cmp_eq_u32 s45, s58
  s_cbranch_scc1 L_gc_6_2
L_gb_6_2:
  s_sub_u32 s47, s47, 1
  s_waitcnt lgkmcnt(6)
  v_mfma_f32_16x16x32_bf16 v[112:115], v[26:29], v[64:67], v[112:115]
  s_cbranch_scc1 L_gn_7_0
  s_branch L_g_6_0
L_g_7_0:
  s_waitcnt lgkmcnt(6)
  s_mov_b32 m0, s84
  v_and_or_b32 v8, v52, s44, v3
  buffer_load_dwordx4 v8, s[8:11], 0 offen lds
  s_waitcnt vmcnt(2)
  ds_read_b64_tr_b16 v[26:27], v17 offset:0
  ds_read_b64_tr_b16 v[28:29], v17 offset:512
  v_readlane_b32 s46, v7, s45
  s_add_u32 s45, s45, 1
  v_and_or_b32 v10, v52, 30, v4
  v_add_u32 v9, s46, v2
  ds_write_b16 v11, v6
  ds_write_b16 v10, v55
  v_mov_b32 v11, v10
  ds_read_b64_tr_b16 v[64:65], v5
  ds_read_b64_tr_b16 v[66:67], v5 offset:512
  ds_read_b32 v51, v9 offset:42240
  v_lshrrev_b32 v9, 1, v9
  ds_read_u16 v54, v9
  s_cmp_eq_u32 s45, s58
  s_cbranch_scc1 L_gc_7_0
L_gb_7_0:
  s_sub_u32 s47, s47, 1
  s_waitcnt lgkmcnt(6)
  v_mfma_f32_16x16x32_bf16 v[116:119], v[26:29], v[56:59], v[116:119]
  s_cbranch_scc1 L_gn_8_1
L_g_7_1:
  s_waitcnt lgkmcnt(6)
  s_mov_b32 m0, s82
  v_and_or_b32 v8, v50, s44, v3
  buffer_load_dwordx4 v8, s[8:11], 0 offen lds
  s_waitcnt vmcnt(2)
  ds_read_b64_tr_b16 v[26:27], v17 offset:1024
  ds_read_b64_tr_b16 v[28:29], v17 offset:1536
  v_readlane_b32 s46, v7, s45
  s_add_u32 s45, s45, 1
  v_and_or_b32 v10, v50, 30, v4
  v_add_u32 v9, s46, v2
  ds_write_b16 v11, v6
  ds_write_b16 v10, v53
  v_mov_b32 v11, v10
  ds_read_b64_tr_b16 v[56:57], v5
  ds_read_b64_tr_b16 v[58:59], v5 offset:512
  ds_read_b32 v52, v9 offset:42240
  v_lshrrev_b32 v9, 1, v9
  ds_read_u16 v55, v9
  s_cmp_eq_u32 s45, s58
  s_cbranch_scc1 L_gc_7_1
L_gb_7_1:
  s_sub_u32 s47, s47, 1
  s_waitcnt lgkmcnt(6)
  v_mfma_f32_16x16x32_bf16 v[116:119], v[26:29], v[60:63], v[116:119]
  s_cbranch_scc1 L_gn_8_2
L_g_7_2:
  s_waitcnt lgkmcnt(6)
  s_mov_b32 m0, s83
  v_and_or_b32 v8, v51, s44, v3
  buffer_load_dwordx4 v8, s[8:11], 0 offen lds
  s_waitcnt vmcnt(2)
  ds_read_b64_tr_b16 v[26:27], v17 offset:2048
  ds_read_b64_tr_b16 v[28:29], v17 offset:2560
  v_readlane_b32 s46, v7, s45
  s_add_u32 s45, s45, 1
  v_and_or_b32 v10, v51, 30, v4
  v_add_u32 v9, s46, v2
  ds_write_b16 v11, v6
  ds_write_b16 v10, v54
  v_mov_b32 v11, v10
  ds_read_b64_tr_b16 v[60:61], v5
  ds_read_b64_tr_b16 v[62:63], v5 offset:512
  ds_read_b32 v50, v9 offset:42240
  v_lshrrev_b32 v9, 1, v9
  ds_read_u16 v53, v9
  s_cmp_eq_u32 s45, s58
  s_cbranch_scc1 L_gc_7_2
L_gb_7_2:
  s_sub_u32 s47, s47, 1
  s_waitcnt lgkmcnt(6)
  v_mfma_f32_16x16x32_bf16 v[116:119], v[26:29], v[64:67], v[116:119]
  s_cbranch_scc1 L_gn_8_0
  s_branch L_g_7_0
L_g_8_0:
  s_waitcnt lgkmcnt(6)
  s_mov_b32 m0, s84
  v_and_or_b32 v8, v52, s44, v3
  buffer_load_dwordx4 v8, s[8:11], 0 offen lds
  s_waitcnt vmcnt(2)
  ds_read_b64_tr_b16 v[26:27], v17 offset:0
  ds_read_b64_tr_b16 v[28:29], v17 offset:512
  v_readlane_b32 s46, v7, s45
  s_add_u32 s45, s45, 1
  v_and_or_b32 v10, v52, 30, v4
  v_add_u32 v9, s46, v2
  ds_write_b16 v11, v6
  ds_write_b16 v10, v55
  v_mov_b32 v11, v10
  ds_read_b64_tr_b16 v[64:65], v5
  ds_read_b64_tr_b16 v[66:67], v5 offset:512
  ds_read_b32 v51, v9 offset:42240
  v_lshrrev_b32 v9, 1, v9
  ds_read_u16 v54, v9
  s_cmp_eq_u32 s45, s58
  s_cbranch_scc1 L_gc_8_0
L_gb_8_0:
  s_sub_u32 s47, s47, 1
  s_waitcnt lgkmcnt(6)
  v_mfma_f32_16x16x32_bf16 v[120:123], v[26:29], v[56:59], v[120:123]
  s_cbranch_scc1 L_gn_9_1
L_g_8_1:
  s_waitcnt lgkmcnt(6)
  s_mov_b32 m0, s82
  v_and_or_b32 v8, v50, s44, v3
  buffer_load_dwordx4 v8, s[8:11], 0 offen lds
  s_waitcnt vmcnt(2)
  ds_read_b64_tr_b16 v[26:27], v17 offset:1024
  ds_read_b64_tr_b16 v[28:29], v17 offset:1536
  v_readlane_b32 s46, v7, s45
  s_add_u32 s45, s45, 1
  v_and_or_b32 v10, v50, 30, v4
  v_add_u32 v9, s46, v2
  ds_write_b16 v11, v6
  ds_write_b16 v10, v53
  v_mov_b32 v11, v10
  ds_read_b64_tr_b16 v[56:57], v5
  ds_read_b64_tr_b16 v[58:59], v5 offset:512
  ds_read_b32 v52, v9 offset:42240
  v_lshrrev_b32 v9, 1, v9
  ds_read_u16 v55, v9
  s_cmp_eq_u32 s45, s58
  s_cbranch_scc1 L_gc_8_1
L_gb_8_1:
  s_sub_u32 s47, s47, 1
  s_waitcnt lgkmcnt(6)
  v_mfma_f32_16x16x32_bf16 v[120:123], v[26:29], v[60:63], v[120:123]
  s_cbranch_scc1 L_gn_9_2
L_g_8_2:
  s_waitcnt lgkmcnt(6)
  s_mov_b32 m0, s83
  v_and_or_b32 v8, v51, s44, v3
  buffer_load_dwordx4 v8, s[8:11], 0 offen lds
  s_waitcnt vmcnt(2)
  ds_read_b64_tr_b16 v[26:27], v17 offset:2048
  ds_read_b64_tr_b16 v[28:29], v17 offset:2560
  v_readlane_b32 s46, v7, s45
  s_add_u32 s45, s45, 1
  v_and_or_b32 v10, v51, 30, v4
  v_add_u32 v9, s46, v2
  ds_write_b16 v11, v6
  ds_write_b16 v10, v54
  v_mov_b32 v11, v10
  ds_read_b64_tr_b16 v[60:61], v5
  ds_read_b64_tr_b16 v[62:63], v5 offset:512
  ds_read_b32 v50, v9 offset:42240
  v_lshrrev_b32 v9, 1, v9
  ds_read_u16 v53, v9
  s_cmp_eq_u32 s45, s58
  s_cbranch_scc1 L_gc_8_2
L_gb_8_2:
  s_sub_u32 s47, s47, 1
  s_waitcnt lgkmcnt(6)
  v_mfma_f32_16x16x32_bf16 v[120:123], v[26:29], v[64:67], v[120:123]
  s_cbranch_scc1 L_gn_9_0
  s_branch L_g_8_0
L_g_9_0:
  s_waitcnt lgkmcnt(6)
  s_mov_b32 m0, s84
  v_and_or_b32 v8, v52, s44, v3
  buffer_load_dwordx4 v8, s[8:11], 0 offen lds
  s_waitcnt vmcnt(2)
  ds_read_b64_tr_b16 v[26:27], v17 offset:0
  ds_read_b64_tr_b16 v[28:29], v17 offset:512
  v_readlane_b32 s46, v7, s45
  s_add_u32 s45, s45, 1
  v_and_or_b32 v10, v52, 30, v4
  v_add_u32 v9, s46, v2
  ds_write_b16 v11, v6
  ds_write_b16 v10, v55
  v_mov_b32 v11, v10
  ds_read_b64_tr_b16 v[64:65], v5
  ds_read_b64_tr_b16 v[66:67], v5 offset:512
  ds_read_b32 v51, v9 offset:42240
  v_lshrrev_b32 v9, 1, v9
  ds_read_u16 v54, v9
  s_cmp_eq_u32 s45, s58
  s_cbranch_scc1 L_gc_9_0
L_gb_9_0:
  s_sub_u32 s47, s47, 1
  s_waitcnt lgkmcnt(6)
  v_mfma_f32_16x16x32_bf16 v[124:127], v[26:29], v[56:59], v[124:127]
  s_cbranch_scc1 L_gn_10_1
L_g_9_1:
  s_waitcnt lgkmcnt(6)
  s_mov_b32 m0, s82
  v_and_or_b32 v8, v50, s44, v3
  buffer_load_dwordx4 v8, s[8:11], 0 offen lds
  s_waitcnt vmcnt(2)
  ds_read_b64_tr_b16 v[26:27], v17 offset:1024
  ds_read_b64_tr_b16 v[28:29], v17 offset:1536
  v_readlane_b32 s46, v7, s45
  s_add_u32 s45, s45, 1
  v_and_or_b32 v10, v50, 30, v4
  v_add_u32 v9, s46, v2
  ds_write_b16 v11, v6
  ds_write_b16 v10, v53
  v_mov_b32 v11, v10
  ds_read_b64_tr_b16 v[56:57], v5
  ds_read_b64_tr_b16 v[58:59], v5 offset:512
  ds_read_b32 v52, v9 offset:42240
  v_lshrrev_b32 v9, 1, v9
  ds_read_u16 v55, v9
  s_cmp_eq_u32 s45, s58
  s_cbranch_scc1 L_gc_9_1
L_gb_9_1:
  s_sub_u32 s47, s47, 1
  s_waitcnt lgkmcnt(6)
  v_mfma_f32_16x16x32_bf16 v[124:127], v[26:29], v[60:63], v[124:127]
  s_cbranch_scc1 L_gn_10_2
L_g_9_2:
  s_waitcnt lgkmcnt(6)
  s_mov_b32 m0, s83
  v_and_or_b32 v8, v51, s44, v3
  buffer_load_dwordx4 v8, s[8:11], 0 offen lds
  s_waitcnt vmcnt(2)
  ds_read_b64_tr_b16 v[26:27], v17 offset:2048
  ds_read_b64_tr_b16 v[28:29], v17 offset:2560
  v_readlane_b32 s46, v7, s45
  s_add_u32 s45, s45, 1
  v_and_or_b32 v10, v51, 30, v4
  v_add_u32 v9, s46, v2
  ds_write_b16 v11, v6
  ds_write_b16 v10, v54
  v_mov_b32 v11, v10
  ds_read_b64_tr_b16 v[60:61], v5
  ds_read_b64_tr_b16 v[62:63], v5 offset:512
  ds_read_b32 v50, v9 offset:42240
  v_lshrrev_b32 v9, 1, v9
  ds_read_u16 v53, v9
  s_cmp_eq_u32 s45, s58
  s_cbranch_scc1 L_gc_9_2
L_gb_9_2:
  s_sub_u32 s47, s47, 1
  s_waitcnt lgkmcnt(6)
  v_mfma_f32_16x16x32_bf16 v[124:127], v[26:29], v[64:67], v[124:127]
  s_cbranch_scc1 L_gn_10_0
  s_branch L_g_9_0
L_gc_0_0:
  s_call_b64 s[30:31], L_setup
  s_branch L_gb_0_0
L_gc_0_1:
  s_call_b64 s[30:31], L_setup
  s_branch L_gb_0_1
L_gc_0_2:
  s_call_b64 s[30:31], L_setup
  s_branch L_gb_0_2
L_gc_1_0:
  s_call_b64 s[30:31], L_setup
  s_branch L_gb_1_0
L_gc_1_1:
  s_call_b64 s[30:31], L_setup
  s_branch L_gb_1_1
L_gc_1_2:
  s_call_b64 s[30:31], L_setup
  s_branch L_gb_1_2
L_gc_2_0:
  s_call_b64 s[30:31], L_setup
  s_branch L_gb_2_0
L_gc_2_1:
  s_call_b64 s[30:31], L_setup
  s_branch L_gb_2_1
L_gc_2_2:
  s_call_b64 s[30:31], L_setup
  s_branch L_gb_2_2
L_gc_3_0:
  s_call_b64 s[30:31], L_setup
  s_branch L_gb_3_0
L_gc_3_1:
  s_call_b64 s[30:31], L_setup
  s_branch L_gb_3_1
L_gc_3_2:
  s_call_b64 s[30:31], L_setup
  s_branch L_gb_3_2
L_gc_4_0:
  s_call_b64 s[30:31], L_setup
  s_branch L_gb_4_0
L_gc_4_1:
  s_call_b64 s[30:31], L_setup
  s_branch L_gb_4_1
L_gc_4_2:
  s_call_b64 s[30:31], L_setup
  s_branch L_gb_4_2
L_gc_5_0:
  s_call_b64 s[30:31], L_setup
  s_branch L_gb_5_0
L_gc_5_1:
  s_call_b64 s[30:31], L_setup
  s_branch L_gb_5_1
L_gc_5_2:
  s_call_b64 s[30:31], L_setup
  s_branch L_gb_5_2
L_gc_6_0:
  s_call_b64 s[30:31], L_setup
  s_branch L_gb_6_0
L_gc_6_1:
  s_call_b64 s[30:31], L_setup
  s_branch L_gb_6_1
L_gc_6_2:
  s_call_b64 s[30:31], L_setup
  s_branch L_gb_6_2
L_gc_7_0:
  s_call_b64 s[30:31], L_setup
  s_branch L_gb_7_0
L_gc_7_1:
  s_call_b64 s[30:31], L_setup
  s_branch L_gb_7_1
L_gc_7_2:
  s_call_b64 s[30:31], L_setup
  s_branch L_gb_7_2
L_gc_8_0:
  s_call_b64 s[30:31], L_setup
  s_branch L_gb_8_0
L_gc_8_1:
  s_call_b64 s[30:31], L_setup
  s_branch L_gb_8_1
L_gc_8_2:
  s_call_b64 s[30:31], L_setup
  s_branch L_gb_8_2
L_gc_9_0:
  s_call_b64 s[30:31], L_setup
  s_branch L_gb_9_0
L_gc_9_1:
  s_call_b64 s[30:31], L_setup
  s_branch L_gb_9_1
L_gc_9_2:
  s_call_b64 s[30:31], L_setup
  s_branch L_gb_9_2
L_gn_0_0:
  s_sub_u32 s47, s48, 1
  s_cbranch_scc1 L_gn_1_0
  s_branch L_g_0_0
L_gn_0_1:
  s_sub_u32 s47, s48, 1
  s_cbranch_scc1 L_gn_1_1
  s_branch L_g_0_1
L_gn_0_2:
  s_sub_u32 s47, s48, 1
  s_cbranch_scc1 L_gn_1_2
  s_branch L_g_0_2
L_gn_1_0:
  s_sub_u32 s47, s49, 1
  s_cbranch_scc1 L_gn_2_0
  s_branch L_g_1_0
L_gn_1_1:
  s_sub_u32 s47, s49, 1
  s_cbranch_scc1 L_gn_2_1
  s_branch L_g_1_1
L_gn_1_2:
  s_sub_u32 s47, s49, 1
  s_cbranch_scc1 L_gn_2_2
  s_branch L_g_1_2
L_gn_2_0:
  s_sub_u32 s47, s50, 1
  s_cbranch_scc1 L_gn_3_0
  s_branch L_g_2_0
L_gn_2_1:
  s_sub_u32 s47, s50, 1
  s_cbranch_scc1 L_gn_3_1
  s_branch L_g_2_1
L_gn_2_2:
  s_sub_u32 s47, s50, 1
  s_cbranch_scc1 L_gn_3_2
  s_branch L_g_2_2
L_gn_3_0:
  s_sub_u32 s47, s51, 1
  s_cbranch_scc1 L_gn_4_0
  s_branch L_g_3_0
L_gn_3_1:
  s_sub_u32 s47, s51, 1
  s_cbranch_scc1 L_gn_4_1
  s_branch L_g_3_1
L_gn_3_2:
  s_sub_u32 s47, s51, 1
  s_cbranch_scc1 L_gn_4_2
  s_branch L_g_3_2
L_gn_4_0:
  s_sub_u32 s47, s52, 1
  s_cbranch_scc1 L_gn_5_0
  s_branch L_g_4_0
L_gn_4_1:
  s_sub_u32 s47, s52, 1
  s_cbranch_scc1 L_gn_5_1
  s_branch L_g_4_1
L_gn_4_2:
  s_sub_u32 s47, s52, 1
  s_cbranch_scc1 L_gn_5_2
  s_branch L_g_4_2
L_gn_5_0:
  s_sub_u32 s47, s53, 1
  s_cbranch_scc1 L_gn_6_0
  s_branch L_g_5_0
L_gn_5_1:
  s_sub_u32 s47, s53, 1
  s_cbranch_scc1 L_gn_6_1
  s_branch L_g_5_1
L_gn_5_2:
  s_sub_u32 s47, s53, 1
  s_cbranch_scc1 L_gn_6_2
  s_branch L_g_5_2
L_gn_6_0:
  s_sub_u32 s47, s54, 1
  s_cbranch_scc1 L_gn_7_0
  s_branch L_g_6_0
L_gn_6_1:
  s_sub_u32 s47, s54, 1
  s_cbranch_scc1 L_gn_7_1
  s_branch L_g_6_1
L_gn_6_2:
  s_sub_u32 s47, s54, 1
  s_cbranch_scc1 L_gn_7_2
  s_branch L_g_6_2
L_gn_7_0:
  s_sub_u32 s47, s55, 1
  s_cbranch_scc1 L_gn_8_0
  s_branch L_g_7_0
L_gn_7_1:
  s_sub_u32 s47, s55, 1
  s_cbranch_scc1 L_gn_8_1
  s_branch L_g_7_1
L_gn_7_2:
  s_sub_u32 s47, s55, 1
  s_cbranch_scc1 L_gn_8_2
  s_branch L_g_7_2
L_gn_8_0:
  s_sub_u32 s47, s56, 1
  s_cbranch_scc1 L_gn_9_0
  s_branch L_g_8_0
L_gn_8_1:
  s_sub_u32 s47, s56, 1
  s_cbranch_scc1 L_gn_9_1
  s_branch L_g_8_1
L_gn_8_2:
  s_sub_u32 s47, s56, 1
  s_cbranch_scc1 L_gn_9_2
  s_branch L_g_8_2
L_gn_9_0:
  s_sub_u32 s47, s57, 1
  s_cbranch_scc1 L_gn_10_0
  s_branch L_g_9_0
L_gn_9_1:
  s_sub_u32 s47, s57, 1
  s_cbranch_scc1 L_gn_10_1
  s_branch L_g_9_1
L_gn_9_2:
  s_sub_u32 s47, s57, 1
  s_cbranch_scc1 L_gn_10_2
  s_branch L_g_9_2
L_gn_10_0:
  s_add_u32 s60, s60, 1
  s_cmp_eq_u32 s60, s61
  s_cbranch_scc1 L_g_end
  s_cmp_lg_u32 s60, 8
  s_cbranch_scc1 L_gz_0
  s_nop 7
  v_mov_b32 v88, 0
  v_mov_b32 v89, 0
  v_mov_b32 v90, 0
  v_mov_b32 v91, 0
  v_mov_b32 v92, 0
  v_mov_b32 v93, 0
  v_mov_b32 v94, 0
  v_mov_b32 v95, 0
  v_mov_b32 v96, 0
  v_mov_b32 v97, 0
  v_mov_b32 v98, 0
  v_mov_b32 v99, 0
  v_mov_b32 v100, 0
  v_mov_b32 v101, 0
  v_mov_b32 v102, 0
  v_mov_b32 v103, 0
  v_mov_b32 v104, 0
  v_mov_b32 v105, 0
  v_mov_b32 v106, 0
  v_mov_b32 v107, 0
  v_mov_b32 v108, 0
  v_mov_b32 v109, 0
  v_mov_b32 v110, 0
  v_mov_b32 v111, 0
  v_mov_b32 v112, 0
  v_mov_b32 v113, 0
  v_mov_b32 v114, 0
  v_mov_b32 v115, 0
  v_mov_b32 v116, 0
  v_mov_b32 v117, 0
  v_mov_b32 v118, 0
  v_mov_b32 v119, 0
  v_mov_b32 v120, 0
  v_mov_b32 v121, 0
  v_mov_b32 v122, 0
  v_mov_b32 v123, 0
  v_mov_b32 v124, 0
  v_mov_b32 v125, 0
  v_mov_b32 v126, 0
  v_mov_b32 v127, 0
L_gz_0:
  s_mov_b64 s[48:49], s[64:65]
  s_mov_b64 s[50:51], s[66:67]
  s_mov_b64 s[52:53], s[68:69]
  s_mov_b64 s[54:55], s[70:71]
  s_mov_b64 s[56:57], s[72:73]
  s_branch L_gn_0_0
L_gn_10_1:
  s_add_u32 s60, s60, 1
  s_cmp_eq_u32 s60, s61
  s_cbranch_scc1 L_g_end
  s_cmp_lg_u32 s60, 8
  s_cbranch_scc1 L_gz_1
  s_nop 7
  v_mov_b32 v88, 0
  v_mov_b32 v89, 0
  v_mov_b32 v90, 0
  v_mov_b32 v91, 0
  v_mov_b32 v92, 0
  v_mov_b32 v93, 0
  v_mov_b32 v94, 0
  v_mov_b32 v95, 0
  v_mov_b32 v96, 0
  v_mov_b32 v97, 0
  v_mov_b32 v98, 0
  v_mov_b32 v99, 0
  v_mov_b32 v100, 0
  v_mov_b32 v101, 0
  v_mov_b32 v102, 0
  v_mov_b32 v103, 0
  v_mov_b32 v104, 0
  v_mov_b32 v105, 0
  v_mov_b32 v106, 0
  v_mov_b32 v107, 0
  v_mov_b32 v108, 0
  v_mov_b32 v109, 0
  v_mov_b32 v110, 0
  v_mov_b32 v111, 0
  v_mov_b32 v112, 0
  v_mov_b32 v113, 0
  v_mov_b32 v114, 0
  v_mov_b32 v115, 0
  v_mov_b32 v116, 0
  v_mov_b32 v117, 0
  v_mov_b32 v118, 0
  v_mov_b32 v119, 0
  v_mov_b32 v120, 0
  v_mov_b32 v121, 0
  v_mov_b32 v122, 0
  v_mov_b32 v123, 0
  v_mov_b32 v124, 0
  v_mov_b32 v125, 0
  v_mov_b32 v126, 0
  v_mov_b32 v127, 0
L_gz_1:
  s_mov_b64 s[48:49], s[64:65]
  s_mov_b64 s[50:51], s[66:67]
  s_mov_b64 s[52:53], s[68:69]
  s_mov_b64 s[54:55], s[70:71]
  s_mov_b64 s[56:57], s[72:73]
  s_branch L_gn_0_1
L_gn_10_2:
  s_add_u32 s60, s60, 1
  s_cmp_eq_u32 s60, s61
  s_cbranch_scc1 L_g_end
  s_cmp_lg_u32 s60, 8
  s_cbranch_scc1 L_gz_2
  s_nop 7
  v_mov_b32 v88, 0
  v_mov_b32 v89, 0
  v_mov_b32 v90, 0
  v_mov_b32 v91, 0
  v_mov_b32 v92, 0
  v_mov_b32 v93, 0
  v_mov_b32 v94, 0
  v_mov_b32 v95, 0
  v_mov_b32 v96, 0
  v_mov_b32 v97, 0
  v_mov_b32 v98, 0
  v_mov_b32 v99, 0
  v_mov_b32 v100, 0
  v_mov_b32 v101, 0
  v_mov_b32 v102, 0
  v_mov_b32 v103, 0
  v_mov_b32 v104, 0
  v_mov_b32 v105, 0
  v_mov_b32 v106, 0
  v_mov_b32 v107, 0
  v_mov_b32 v108, 0
  v_mov_b32 v109, 0
  v_mov_b32 v110, 0
  v_mov_b32 v111, 0
  v_mov_b32 v112, 0
  v_mov_b32 v113, 0
  v_mov_b32 v114, 0
  v_mov_b32 v115, 0
  v_mov_b32 v116, 0
  v_mov_b32 v117, 0
  v_mov_b32 v118, 0
  v_mov_b32 v119, 0
  v_mov_b32 v120, 0
  v_mov_b32 v121, 0
  v_mov_b32 v122, 0
  v_mov_b32 v123, 0
  v_mov_b32 v124, 0
  v_mov_b32 v125, 0
  v_mov_b32 v126, 0
  v_mov_b32 v127, 0
L_gz_2:
  s_mov_b64 s[48:49], s[64:65]
  s_mov_b64 s[50:51], s[66:67]
  s_mov_b64 s[52:53], s[68:69]
  s_mov_b64 s[54:55], s[70:71]
  s_mov_b64 s[56:57], s[72:73]
  s_branch L_gn_0_2
L_setup:
  s_waitcnt lgkmcnt(0)
  s_cmp_lt_i32 s59, 0
  s_cbranch_scc1 L_su_nosig
  s_and_b32 s75, s59, 1
  v_mov_b32 v68, 0xffffe0
  v_mov_b32 v72, 0
  v_mov_b32 v69, 0xffffe0
  v_mov_b32 v73, 0
  v_mov_b32 v70, 0xffffe0
  v_mov_b32 v74, 0
  v_mov_b32 v71, 0xffffe0
  v_mov_b32 v75, 0
  s_mul_i32 s76, s75, 42240
  s_mul_i32 s77, s35, 5280
  s_add_u32 s76, s76, s77
  v_add_u32 v9, s76, v16
  ds_write_b128 v9, v[68:71] offset:42240
  ds_write_b128 v9, v[68:71] offset:43264
  ds_write_b128 v9, v[68:71] offset:44288
  ds_write_b128 v9, v[68:71] offset:45312
  ds_write_b128 v9, v[68:71] offset:46336
  s_mov_b64 exec, 0x3ff
  ds_write_b128 v9, v[68:71] offset:47360
  s_mov_b64 exec, -1
  s_lshr_b32 s76, s76, 1
  v_add_u32 v9, s76, v16
  ds_write_b128 v9, v[72:75]
  ds_write_b128 v9, v[72:75] offset:1024
  s_bfm_b64 exec, 37, 0
  ds_write_b128 v9, v[72:75] offset:2048
  s_mov_b64 exec, -1
  s_lshl_b32 s75, s75, 2
  v_add_u32 v9, s75, v12
  s_waitcnt lgkmcnt(0)
  s_mov_b64 exec, 1
  ds_add_u32 v9, v13 offset:12
  s_mov_b64 exec, -1
L_su_nosig:
  s_add_u32 s59, s59, 1
  v_lshrrev_b32 v8, 2, v16
  s_lshl_b32 s76, s35, 8
  s_add_u32 s76, s76, 135168
  v_add_u32 v8, s76, v8
  s_cmp_lg_u32 s59, 8
  s_cbranch_scc1 L_su_noovf
  ds_read_b32 v10, v12 offset:0
  s_waitcnt lgkmcnt(0)
  v_readfirstlane_b32 s77, v10
  s_nop 3
  s_cmp_eq_u32 s77, 0
  s_cbranch_scc1 L_su_noovf
  s_mov_b32 s61, 0x7fffffff
L_su_noovf:
  s_cmp_lt_u32 s59, s61
  s_cbranch_scc1 L_su_real
  v_mov_b32 v7, 41712
  s_mov_b32 s58, 0x7fffffff
  s_mov_b32 s45, 0
  s_setpc_b64 s[30:31]
L_su_real:
  v_mov_b32 v7, 41712
  ds_write_b32 v8, v7
  s_and_b32 s75, s59, 1
  s_lshl_b32 s77, s75, 2
  v_add_u32 v9, s77, v12
  s_lshr_b32 s77, s59, 1
  s_add_u32 s77, s77, 1
  s_mul_i32 s77, s77, 8
L_su_poll:
  ds_read_b32 v10, v9 offset:4
  s_waitcnt lgkmcnt(0)
  v_readfirstlane_b32 s78, v10
  s_nop 3
  s_cmp_ge_u32 s78, s77
  s_cbranch_scc1 L_su_poll_ok
  s_sleep 2
  s_branch L_su_poll
L_su_poll_ok:
  s_cmp_lt_u32 s59, 8
  s_cbranch_scc1 L_su_nolast
  ds_read_b32 v10, v12 offset:68
  s_waitcnt lgkmcnt(0)
  v_readfirstlane_b32 s77, v10
  s_add_u32 s78, s59, 1
  s_nop 2
  s_cmp_eq_u32 s77, s78
  s_cselect_b32 s61, s78, s61
L_su_nolast:
  s_lshl_b32 s77, s75, 9
  s_mul_i32 s78, s35, 40
  s_add_u32 s77, s77, s78
  s_add_u32 s77, s77, 137216
  v_lshrrev_b32 v9, 2, v16
  v_add_u32 v9, s77, v9
  s_mov_b64 exec, 0x3ff
  v_mov_b32 v68, 0
  s_mov_b64 exec, -1
  v_mov_b32 v68, 0
  s_mov_b64 exec, 0x3ff
  ds_read_b32 v68, v9
  s_waitcnt lgkmcnt(0)
  ds_write_b32 v9, v6
  s_mov_b64 exec, -1
  v_min_u32 v68, 128, v68
  v_add_u32 v68, 31, v68
  v_lshrrev_b32 v68, 5, v68
  v_mov_b32 v69, v68
  s_mul_i32 s77, s75, 42240
  s_mul_i32 s78, s35, 5280
  s_add_u32 s77, s77, s78
  v_add_u32_dpp v69, v69, v69 row_shr:1 row_mask:0xf bank_mask:0xf bound_ctrl:0
  s_nop 0
  s_nop 0
  v_add_u32_dpp v69, v69, v69 row_shr:2 row_mask:0xf bank_mask:0xf bound_ctrl:0
  s_nop 0
  s_nop 0
  v_add_u32_dpp v69, v69, v69 row_shr:4 row_mask:0xf bank_mask:0xf bound_ctrl:0
  s_nop 0
  s_nop 0
  v_add_u32_dpp v69, v69, v69 row_shr:8 row_mask:0xf bank_mask:0xf bound_ctrl:0
  s_nop 0
  v_add_u32 v70, s77, v14
  v_sub_u32 v71, v69, v68
  v_lshl_add_u32 v71, v71, 2, s76
  v_cmp_lt_u32 vcc, 0, v68
  s_and_saveexec_b64 s[78:79], vcc
  ds_write_b32 v71, v70 offset:0
  s_mov_b64 exec, s[78:79]
  v_add_u32 v70, 128, v70
  v_cmp_lt_u32 vcc, 1, v68
  s_and_saveexec_b64 s[78:79], vcc
  ds_write_b32 v71, v70 offset:4
  s_mov_b64 exec, s[78:79]
  v_add_u32 v70, 128, v70
  v_cmp_lt_u32 vcc, 2, v68
  s_and_saveexec_b64 s[78:79], vcc
  ds_write_b32 v71, v70 offset:8
  s_mov_b64 exec, s[78:79]
  v_add_u32 v70, 128, v70
  v_cmp_lt_u32 vcc, 3, v68
  s_and_saveexec_b64 s[78:79], vcc
  ds_write_b32 v71, v70 offset:12
  s_mov_b64 exec, s[78:79]
  ds_read_b32 v7, v8
  v_readlane_b32 s64, v68, 0
  v_readlane_b32 s65, v68, 1
  v_readlane_b32 s66, v68, 2
  v_readlane_b32 s67, v68, 3
  v_readlane_b32 s68, v68, 4
  v_readlane_b32 s69, v68, 5
  v_readlane_b32 s70, v68, 6
  v_readlane_b32 s71, v68, 7
  v_readlane_b32 s72, v68, 8
  v_readlane_b32 s73, v68, 9
  v_readlane_b32 s77, v69, 9
  s_nop 2
  s_max_u32 s58, s77, 5
  s_sub_u32 s77, s58, s77
  s_add_u32 s73, s73, s77
  s_mov_b32 s45, 0
  s_waitcnt lgkmcnt(0)
  s_setpc_b64 s[30:31]
L_g_end:
  s_waitcnt vmcnt(0) lgkmcnt(0)
  s_nop 7
  s_mul_i32 s76, s35, 5280
  s_add_u32 s76, s76, 42240
  v_add_u32 v9, s76, v16
  ds_write_b128 v9, v[88:91] offset:0
  ds_write_b128 v9, v[92:95] offset:1024
  ds_write_b128 v9, v[96:99] offset:2048
  ds_write_b128 v9, v[100:103] offset:3072
  ds_write_b128 v9, v[104:107] offset:4096
  ds_write_b128 v9, v[108:111] offset:42240
  ds_write_b128 v9, v[112:115] offset:43264
  ds_write_b128 v9, v[116:119] offset:44288
  ds_write_b128 v9, v[120:123] offset:45312
  ds_write_b128 v9, v[124:127] offset:46336
  s_lshl_b32 s76, s35, 2
  v_add_u32 v9, s76, v12
  s_waitcnt lgkmcnt(0)
  s_mov_b64 exec, 1
  ds_write_b32 v9, v13 offset:32
  s_mov_b64 exec, -1
  s_waitcnt lgkmcnt(0)
L_k2_end:
  s_endpgm
L_k2_iwave:
  s_setprio 0
  s_sub_u32 s60, s35, 8
  s_lshl_b32 s60, s60, 5
  s_mov_b32 s52, 0x1fc
  s_mov_b64 s[54:55], 0
  v_mov_b32 v101, 0x7fffff00
  v_add_u32 v102, s60, v1
  v_cmp_gt_u32 vcc, 250, v102
  v_cmp_gt_u32 s[40:41], 32, v1
  v_lshlrev_b32 v102, 2, v1
  s_and_b64 vcc, vcc, s[40:41]
  s_nop 1
  v_cndmask_b32 v102, v101, v102, vcc
  s_mov_b32 s61, 0
  s_add_u32 s59, s61, 0
  s_lshr_b32 s58, s59, 1
  s_add_u32 s58, s58, s2
  s_and_b32 s58, s58, 3
  s_lshl_b32 s58, s58, 8
  s_add_u32 s58, s58, s3
  s_lshl_b32 s58, s58, 9
  s_and_b32 s59, s59, 1
  s_mul_i32 s59, s59, 250
  s_add_u32 s59, s59, s60
  s_add_u32 s58, s58, s59
  s_lshl_b32 s58, s58, 2
  buffer_load_dword v103, v102, s[16:19], s58 offen
  s_add_u32 s59, s61, 1
  s_lshr_b32 s58, s59, 1
  s_add_u32 s58, s58, s2
  s_and_b32 s58, s58, 3
  s_lshl_b32 s58, s58, 8
  s_add_u32 s58, s58, s3
  s_lshl_b32 s58, s58, 9
  s_and_b32 s59, s59, 1
  s_mul_i32 s59, s59, 250
  s_add_u32 s59, s59, s60
  s_add_u32 s58, s58, s59
  s_lshl_b32 s58, s58, 2
  buffer_load_dword v104, v102, s[16:19], s58 offen
  s_add_u32 s59, s61, 2
  s_lshr_b32 s58, s59, 1
  s_add_u32 s58, s58, s2
  s_and_b32 s58, s58, 3
  s_lshl_b32 s58, s58, 8
  s_add_u32 s58, s58, s3
  s_lshl_b32 s58, s58, 9
  s_and_b32 s59, s59, 1
  s_mul_i32 s59, s59, 250
  s_add_u32 s59, s59, s60
  s_add_u32 s58, s58, s59
  s_lshl_b32 s58, s58, 2
  buffer_load_dword v105, v102, s[16:19], s58 offen
  v_mov_b32 v97, 1
  v_mov_b32 v108, 132
  v_lshrrev_b32 v98, 4, v1
  v_mov_b32 v100, 129024
  v_mul_lo_u32 v100, v100, v98
  v_lshlrev_b32 v98, 2, v98
  v_and_b32 v99, 15, v1
  v_mov_b32 v109, 138240
  s_waitcnt vmcnt(2)
  s_add_u32 s57, s61, 0
  s_and_b32 s57, s57, 1
  s_mul_i32 s57, s57, 250
  s_add_u32 s57, s57, s60
  s_mul_i32 s57, s57, 129024
  ds_bpermute_b32 v16, v98, v103 offset:0
  ds_bpermute_b32 v20, v98, v103 offset:16
  ds_bpermute_b32 v24, v98, v103 offset:32
  ds_bpermute_b32 v28, v98, v103 offset:48
  ds_bpermute_b32 v32, v98, v103 offset:64
  ds_bpermute_b32 v36, v98, v103 offset:80
  ds_bpermute_b32 v40, v98, v103 offset:96
  ds_bpermute_b32 v44, v98, v103 offset:112
  s_waitcnt lgkmcnt(7)
  v_and_b32 v106, 0xffff, v16
  v_lshrrev_b32 v107, 16, v16
  v_add_u32 v106, v106, v99
  v_cmp_lt_u32 vcc, v106, v107
  v_mad_u32_u24 v106, v106, 12, v100
  s_nop 0
  v_cndmask_b32 v106, v101, v106, vcc
  buffer_load_dwordx3 v[16:18], v106, s[12:15], s57 offen
  s_add_u32 s57, s57, 516096
  s_waitcnt lgkmcnt(6)
  v_and_b32 v106, 0xffff, v20
  v_lshrrev_b32 v107, 16, v20
  v_add_u32 v106, v106, v99
  v_cmp_lt_u32 vcc, v106, v107
  v_mad_u32_u24 v106, v106, 12, v100
  s_nop 0
  v_cndmask_b32 v106, v101, v106, vcc
  buffer_load_dwordx3 v[20:22], v106, s[12:15], s57 offen
  s_add_u32 s57, s57, 516096
  s_waitcnt lgkmcnt(5)
  v_and_b32 v106, 0xffff, v24
  v_lshrrev_b32 v107, 16, v24
  v_add_u32 v106, v106, v99
  v_cmp_lt_u32 vcc, v106, v107
  v_mad_u32_u24 v106, v106, 12, v100
  s_nop 0
  v_cndmask_b32 v106, v101, v106, vcc
  buffer_load_dwordx3 v[24:26], v106, s[12:15], s57 offen
  s_add_u32 s57, s57, 516096
  s_waitcnt lgkmcnt(4)
  v_and_b32 v106, 0xffff, v28
  v_lshrrev_b32 v107, 16, v28
  v_add_u32 v106, v106, v99
  v_cmp_lt_u32 vcc, v106, v107
  v_mad_u32_u24 v106, v106, 12, v100
  s_nop 0
  v_cndmask_b32 v106, v101, v106, vcc
  buffer_load_dwordx3 v[28:30], v106, s[12:15], s57 offen
  s_add_u32 s57, s57, 516096
  s_waitcnt lgkmcnt(3)
  v_and_b32 v106, 0xffff, v32
  v_lshrrev_b32 v107, 16, v32
  v_add_u32 v106, v106, v99
  v_cmp_lt_u32 vcc, v106, v107
  v_mad_u32_u24 v106, v106, 12, v100
  s_nop 0
  v_cndmask_b32 v106, v101, v106, vcc
  buffer_load_dwordx3 v[32:34], v106, s[12:15], s57 offen
  s_add_u32 s57, s57, 516096
  s_waitcnt lgkmcnt(2)
  v_and_b32 v106, 0xffff, v36
  v_lshrrev_b32 v107, 16, v36
  v_add_u32 v106, v106, v99
  v_cmp_lt_u32 vcc, v106, v107
  v_mad_u32_u24 v106, v106, 12, v100
  s_nop 0
  v_cndmask_b32 v106, v101, v106, vcc
  buffer_load_dwordx3 v[36:38], v106, s[12:15], s57 offen
  s_add_u32 s57, s57, 516096
  s_waitcnt lgkmcnt(1)
  v_and_b32 v106, 0xffff, v40
  v_lshrrev_b32 v107, 16, v40
  v_add_u32 v106, v106, v99
  v_cmp_lt_u32 vcc, v106, v107
  v_mad_u32_u24 v106, v106, 12, v100
  s_nop 0
  v_cndmask_b32 v106, v101, v106, vcc
  buffer_load_dwordx3 v[40:42], v106, s[12:15], s57 offen
  s_add_u32 s57, s57, 516096
  s_waitcnt lgkmcnt(0)
  v_and_b32 v106, 0xffff, v44
  v_lshrrev_b32 v107, 16, v44
  v_add_u32 v106, v106, v99
  v_cmp_lt_u32 vcc, v106, v107
  v_mad_u32_u24 v106, v106, 12, v100
  s_nop 0
  v_cndmask_b32 v106, v101, v106, vcc
  buffer_load_dwordx3 v[44:46], v106, s[12:15], s57 offen
  s_waitcnt vmcnt(9)
  s_add_u32 s57, s61, 1
  s_and_b32 s57, s57, 1
  s_mul_i32 s57, s57, 250
  s_add_u32 s57, s57, s60
  s_mul_i32 s57, s57, 129024
  ds_bpermute_b32 v48, v98, v104 offset:0
  ds_bpermute_b32 v52, v98, v104 offset:16
  ds_bpermute_b32 v56, v98, v104 offset:32
  ds_bpermute_b32 v60, v98, v104 offset:48
  ds_bpermute_b32 v64, v98, v104 offset:64
  ds_bpermute_b32 v68, v98, v104 offset:80
  ds_bpermute_b32 v72, v98, v104 offset:96
  ds_bpermute_b32 v76, v98, v104 offset:112
  s_waitcnt lgkmcnt(7)
  v_and_b32 v106, 0xffff, v48
  v_lshrrev_b32 v107, 16, v48
  v_add_u32 v106, v106, v99
  v_cmp_lt_u32 vcc, v106, v107
  v_mad_u32_u24 v106, v106, 12, v100
  s_nop 0
  v_cndmask_b32 v106, v101, v106, vcc
  buffer_load_dwordx3 v[48:50], v106, s[12:15], s57 offen
  s_add_u32 s57, s57, 516096
  s_waitcnt lgkmcnt(6)
  v_and_b32 v106, 0xffff, v52
  v_lshrrev_b32 v107, 16, v52
  v_add_u32 v106, v106, v99
  v_cmp_lt_u32 vcc, v106, v107
  v_mad_u32_u24 v106, v106, 12, v100
  s_nop 0
  v_cndmask_b32 v106, v101, v106, vcc
  buffer_load_dwordx3 v[52:54], v106, s[12:15], s57 offen
  s_add_u32 s57, s57, 516096
  s_waitcnt lgkmcnt(5)
  v_and_b32 v106, 0xffff, v56
  v_lshrrev_b32 v107, 16, v56
  v_add_u32 v106, v106, v99
  v_cmp_lt_u32 vcc, v106, v107
  v_mad_u32_u24 v106, v106, 12, v100
  s_nop 0
  v_cndmask_b32 v106, v101, v106, vcc
  buffer_load_dwordx3 v[56:58], v106, s[12:15], s57 offen
  s_add_u32 s57, s57, 516096
  s_waitcnt lgkmcnt(4)
  v_and_b32 v106, 0xffff, v60
  v_lshrrev_b32 v107, 16, v60
  v_add_u32 v106, v106, v99
  v_cmp_lt_u32 vcc, v106, v107
  v_mad_u32_u24 v106, v106, 12, v100
  s_nop 0
  v_cndmask_b32 v106, v101, v106, vcc
  buffer_load_dwordx3 v[60:62], v106, s[12:15], s57 offen
  s_add_u32 s57, s57, 516096
  s_waitcnt lgkmcnt(3)
  v_and_b32 v106, 0xffff, v64
  v_lshrrev_b32 v107, 16, v64
  v_add_u32 v106, v106, v99
  v_cmp_lt_u32 vcc, v106, v107
  v_mad_u32_u24 v106, v106, 12, v100
  s_nop 0
  v_cndmask_b32 v106, v101, v106, vcc
  buffer_load_dwordx3 v[64:66], v106, s[12:15], s57 offen
  s_add_u32 s57, s57, 516096
  s_waitcnt lgkmcnt(2)
  v_and_b32 v106, 0xffff, v68
  v_lshrrev_b32 v107, 16, v68
  v_add_u32 v106, v106, v99
  v_cmp_lt_u32 vcc, v106, v107
  v_mad_u32_u24 v106, v106, 12, v100
  s_nop 0
  v_cndmask_b32 v106, v101, v106, vcc
  buffer_load_dwordx3 v[68:70], v106, s[12:15], s57 offen
  s_add_u32 s57, s57, 516096
  s_waitcnt lgkmcnt(1)
  v_and_b32 v106, 0xffff, v72
  v_lshrrev_b32 v107, 16, v72
  v_add_u32 v106, v106, v99
  v_cmp_lt_u32 vcc, v106, v107
  v_mad_u32_u24 v106, v106, 12, v100
  s_nop 0
  v_cndmask_b32 v106, v101, v106, vcc
  buffer_load_dwordx3 v[72:74], v106, s[12:15], s57 offen
  s_add_u32 s57, s57, 516096
  s_waitcnt lgkmcnt(0)
  v_and_b32 v106, 0xffff, v76
  v_lshrrev_b32 v107, 16, v76
  v_add_u32 v106, v106, v99
  v_cmp_lt_u32 vcc, v106, v107
  v_mad_u32_u24 v106, v106, 12, v100
  s_nop 0
  v_cndmask_b32 v106, v101, v106, vcc
  buffer_load_dwordx3 v[76:78], v106, s[12:15], s57 offen
  s_barrier
  s_waitcnt vmcnt(8)
L_iw_loop:
  s_lshr_b32 s87, s61, 1
  s_mul_i32 s87, s87, 8
L_iw0_poll:
  ds_read_b32 v106, v109 offset:12
  s_waitcnt lgkmcnt(0)
  v_readfirstlane_b32 s88, v106
  s_nop 3
  s_cmp_ge_u32 s88, s87
  s_cbranch_scc1 L_iw0_poll_ok
  s_sleep 24
  s_branch L_iw0_poll
L_iw0_poll_ok:
  v_mov_b32 v96, 137216
  s_mov_b32 s53, 0xfeeba000
  s_waitcnt vmcnt(9)
  v_cmp_gt_i32 s[64:65], 0, v16
  v_lshrrev_b32 v80, 22, v16
  v_and_or_b32 v80, v80, s52, v96
  v_cmp_gt_i32 s[66:67], 0, v17
  v_lshrrev_b32 v81, 22, v17
  v_and_or_b32 v81, v81, s52, v96
  s_mov_b64 exec, s[64:65]
  ds_add_rtn_u32 v88, v80, v97
  s_mov_b64 exec, s[66:67]
  ds_add_rtn_u32 v89, v81, v97
  s_mov_b64 exec, -1
  v_cmp_gt_i32 s[68:69], 0, v20
  v_lshrrev_b32 v82, 22, v20
  v_and_or_b32 v82, v82, s52, v96
  v_cmp_gt_i32 s[70:71], 0, v21
  v_lshrrev_b32 v83, 22, v21
  v_and_or_b32 v83, v83, s52, v96
  s_mov_b64 exec, s[68:69]
  ds_add_rtn_u32 v90, v82, v97
  s_mov_b64 exec, s[70:71]
  ds_add_rtn_u32 v91, v83, v97
  s_mov_b64 exec, -1
  v_cmp_gt_i32 s[72:73], 0, v24
  v_lshrrev_b32 v84, 22, v24
  v_and_or_b32 v84, v84, s52, v96
  v_cmp_gt_i32 s[74:75], 0, v25
  v_lshrrev_b32 v85, 22, v25
  v_and_or_b32 v85, v85, s52, v96
  s_mov_b64 exec, s[72:73]
  ds_add_rtn_u32 v92, v84, v97
  s_mov_b64 exec, s[74:75]
  ds_add_rtn_u32 v93, v85, v97
  s_mov_b64 exec, -1
  v_cmp_gt_i32 s[76:77], 0, v28
  v_lshrrev_b32 v86, 22, v28
  v_and_or_b32 v86, v86, s52, v96
  v_cmp_gt_i32 s[78:79], 0, v29
  v_lshrrev_b32 v87, 22, v29
  v_and_or_b32 v87, v87, s52, v96
  s_mov_b64 exec, s[76:77]
  ds_add_rtn_u32 v94, v86, v97
  s_mov_b64 exec, s[78:79]
  ds_add_rtn_u32 v95, v87, v97
  s_mov_b64 exec, -1
  s_waitcnt lgkmcnt(6)
  s_mov_b64 exec, s[64:65]
  v_cmp_lt_u32 vcc, 127, v88
  v_min_u32 v88, 127, v88
  v_mad_u32_u24 v80, v80, v108, s53
  s_or_b64 s[54:55], s[54:55], vcc
  v_lshl_add_u32 v80, v88, 2, v80
  ds_write_b32 v80, v16 offset:42240
  v_lshrrev_b32 v88, 1, v80
  ds_write_b16 v88, v18
  s_mov_b64 exec, s[66:67]
  v_cmp_lt_u32 vcc, 127, v89
  v_min_u32 v89, 127, v89
  v_mad_u32_u24 v81, v81, v108, s53
  s_or_b64 s[54:55], s[54:55], vcc
  v_lshl_add_u32 v81, v89, 2, v81
  ds_write_b32 v81, v17 offset:42240
  v_lshrrev_b32 v89, 1, v81
  ds_write_b16_d16_hi v89, v18
  s_mov_b64 exec, -1
  v_cmp_gt_i32 s[64:65], 0, v32
  v_lshrrev_b32 v80, 22, v32
  v_and_or_b32 v80, v80, s52, v96
  v_cmp_gt_i32 s[66:67], 0, v33
  v_lshrrev_b32 v81, 22, v33
  v_and_or_b32 v81, v81, s52, v96
  s_mov_b64 exec, s[64:65]
  ds_add_rtn_u32 v88, v80, v97
  s_mov_b64 exec, s[66:67]
  ds_add_rtn_u32 v89, v81, v97
  s_mov_b64 exec, -1
  s_waitcnt lgkmcnt(10)
  s_mov_b64 exec, s[68:69]
  v_cmp_lt_u32 vcc, 127, v90
  v_min_u32 v90, 127, v90
  v_mad_u32_u24 v82, v82, v108, s53
  s_or_b64 s[54:55], s[54:55], vcc
  v_lshl_add_u32 v82, v90, 2, v82
  ds_write_b32 v82, v20 offset:42240
  v_lshrrev_b32 v90, 1, v82
  ds_write_b16 v90, v22
  s_mov_b64 exec, s[70:71]
  v_cmp_lt_u32 vcc, 127, v91
  v_min_u32 v91, 127, v91
  v_mad_u32_u24 v83, v83, v108, s53
  s_or_b64 s[54:55], s[54:55], vcc
  v_lshl_add_u32 v83, v91, 2, v83
  ds_write_b32 v83, v21 offset:42240
  v_lshrrev_b32 v91, 1, v83
  ds_write_b16_d16_hi v91, v22
  s_mov_b64 exec, -1
  v_cmp_gt_i32 s[68:69], 0, v36
  v_lshrrev_b32 v82, 22, v36
  v_and_or_b32 v82, v82, s52, v96
  v_cmp_gt_i32 s[70:71], 0, v37
  v_lshrrev_b32 v83, 22, v37
  v_and_or_b32 v83, v83, s52, v96
  s_mov_b64 exec, s[68:69]
  ds_add_rtn_u32 v90, v82, v97
  s_mov_b64 exec, s[70:71]
  ds_add_rtn_u32 v91, v83, v97
  s_mov_b64 exec, -1
  s_waitcnt lgkmcnt(14)
  s_mov_b64 exec, s[72:73]
  v_cmp_lt_u32 vcc, 127, v92
  v_min_u32 v92, 127, v92
  v_mad_u32_u24 v84, v84, v108, s53
  s_or_b64 s[54:55], s[54:55], vcc
  v_lshl_add_u32 v84, v92, 2, v84
  ds_write_b32 v84, v24 offset:42240
  v_lshrrev_b32 v92, 1, v84
  ds_write_b16 v92, v26
  s_mov_b64 exec, s[74:75]
  v_cmp_lt_u32 vcc, 127, v93
  v_min_u32 v93, 127, v93
  v_mad_u32_u24 v85, v85, v108, s53
  s_or_b64 s[54:55], s[54:55], vcc
  v_lshl_add_u32 v85, v93, 2, v85
  ds_write_b32 v85, v25 offset:42240
  v_lshrrev_b32 v93, 1, v85
  ds_write_b16_d16_hi v93, v26
  s_mov_b64 exec, -1
  v_cmp_gt_i32 s[72:73], 0, v40
  v_lshrrev_b32 v84, 22, v40
  v_and_or_b32 v84, v84, s52, v96
  v_cmp_gt_i32 s[74:75], 0, v41
  v_lshrrev_b32 v85, 22, v41
  v_and_or_b32 v85, v85, s52, v96
  s_mov_b64 exec, s[72:73]
  ds_add_rtn_u32 v92, v84, v97
  s_mov_b64 exec, s[74:75]
  ds_add_rtn_u32 v93, v85, v97
  s_mov_b64 exec, -1
  s_waitcnt lgkmcnt(15)
  s_mov_b64 exec, s[76:77]
  v_cmp_lt_u32 vcc, 127, v94
  v_min_u32 v94, 127, v94
  v_mad_u32_u24 v86, v86, v108, s53
  s_or_b64 s[54:55], s[54:55], vcc
  v_lshl_add_u32 v86, v94, 2, v86
  ds_write_b32 v86, v28 offset:42240
  v_lshrrev_b32 v94, 1, v86
  ds_write_b16 v94, v30
  s_mov_b64 exec, s[78:79]
  v_cmp_lt_u32 vcc, 127, v95
  v_min_u32 v95, 127, v95
  v_mad_u32_u24 v87, v87, v108, s53
  s_or_b64 s[54:55], s[54:55], vcc
  v_lshl_add_u32 v87, v95, 2, v87
  ds_write_b32 v87, v29 offset:42240
  v_lshrrev_b32 v95, 1, v87
  ds_write_b16_d16_hi v95, v30
  s_mov_b64 exec, -1
  v_cmp_gt_i32 s[76:77], 0, v44
  v_lshrrev_b32 v86, 22, v44
  v_and_or_b32 v86, v86, s52, v96
  v_cmp_gt_i32 s[78:79], 0, v45
  v_lshrrev_b32 v87, 22, v45
  v_and_or_b32 v87, v87, s52, v96
  s_mov_b64 exec, s[76:77]
  ds_add_rtn_u32 v94, v86, v97
  s_mov_b64 exec, s[78:79]
  ds_add_rtn_u32 v95, v87, v97
  s_mov_b64 exec, -1
  s_waitcnt lgkmcnt(15)
  s_mov_b64 exec, s[64:65]
  v_cmp_lt_u32 vcc, 127, v88
  v_min_u32 v88, 127, v88
  v_mad_u32_u24 v80, v80, v108, s53
  s_or_b64 s[54:55], s[54:55], vcc
  v_lshl_add_u32 v80, v88, 2, v80
  ds_write_b32 v80, v32 offset:42240
  v_lshrrev_b32 v88, 1, v80
  ds_write_b16 v88, v34
  s_mov_b64 exec, s[66:67]
  v_cmp_lt_u32 vcc, 127, v89
  v_min_u32 v89, 127, v89
  v_mad_u32_u24 v81, v81, v108, s53
  s_or_b64 s[54:55], s[54:55], vcc
  v_lshl_add_u32 v81, v89, 2, v81
  ds_write_b32 v81, v33 offset:42240
  v_lshrrev_b32 v89, 1, v81
  ds_write_b16_d16_hi v89, v34
  s_mov_b64 exec, -1
  s_waitcnt lgkmcnt(15)
  s_mov_b64 exec, s[68:69]
  v_cmp_lt_u32 vcc, 127, v90
  v_min_u32 v90, 127, v90
  v_mad_u32_u24 v82, v82, v108, s53
  s_or_b64 s[54:55], s[54:55], vcc
  v_lshl_add_u32 v82, v90, 2, v82
  ds_write_b32 v82, v36 offset:42240
  v_lshrrev_b32 v90, 1, v82
  ds_write_b16 v90, v38
  s_mov_b64 exec, s[70:71]
  v_cmp_lt_u32 vcc, 127, v91
  v_min_u32 v91, 127, v91
  v_mad_u32_u24 v83, v83, v108, s53
  s_or_b64 s[54:55], s[54:55], vcc
  v_lshl_add_u32 v83, v91, 2, v83
  ds_write_b32 v83, v37 offset:42240
  v_lshrrev_b32 v91, 1, v83
  ds_write_b16_d16_hi v91, v38
  s_mov_b64 exec, -1
  s_waitcnt lgkmcnt(14)
  s_mov_b64 exec, s[72:73]
  v_cmp_lt_u32 vcc, 127, v92
  v_min_u32 v92, 127, v92
  v_mad_u32_u24 v84, v84, v108, s53
  s_or_b64 s[54:55], s[54:55], vcc
  v_lshl_add_u32 v84, v92, 2, v84
  ds_write_b32 v84, v40 offset:42240
  v_lshrrev_b32 v92, 1, v84
  ds_write_b16 v92, v42
  s_mov_b64 exec, s[74:75]
  v_cmp_lt_u32 vcc, 127, v93
  v_min_u32 v93, 127, v93
  v_mad_u32_u24 v85, v85, v108, s53
  s_or_b64 s[54:55], s[54:55], vcc
  v_lshl_add_u32 v85, v93, 2, v85
  ds_write_b32 v85, v41 offset:42240
  v_lshrrev_b32 v93, 1, v85
  ds_write_b16_d16_hi v93, v42
  s_mov_b64 exec, -1
  s_waitcnt lgkmcnt(12)
  s_mov_b64 exec, s[76:77]
  v_cmp_lt_u32 vcc, 127, v94
  v_min_u32 v94, 127, v94
  v_mad_u32_u24 v86, v86, v108, s53
  s_or_b64 s[54:55], s[54:55], vcc
  v_lshl_add_u32 v86, v94, 2, v86
  ds_write_b32 v86, v44 offset:42240
  v_lshrrev_b32 v94, 1, v86
  ds_write_b16 v94, v46
  s_mov_b64 exec, s[78:79]
  v_cmp_lt_u32 vcc, 127, v95
  v_min_u32 v95, 127, v95
  v_mad_u32_u24 v87, v87, v108, s53
  s_or_b64 s[54:55], s[54:55], vcc
  v_lshl_add_u32 v87, v95, 2, v87
  ds_write_b32 v87, v45 offset:42240
  v_lshrrev_b32 v95, 1, v87
  ds_write_b16_d16_hi v95, v46
  s_mov_b64 exec, -1
  v_and_b32 v106, 0xffff, v103
  v_lshrrev_b32 v107, 16, v103
  v_add_u32 v106, 16, v106
  v_cmp_lt_u32 s[80:81], v106, v107
  s_add_u32 s86, s61, 0
  s_and_b32 s86, s86, 1
  s_mul_i32 s86, s86, 250
  s_add_u32 s86, s86, s60
L_iw0_long:
  s_cmp_eq_u64 s[80:81], 0
  s_cbranch_scc1 L_iw0_long_done
  s_ff1_i32_b64 s82, s[80:81]
  s_bitset0_b64 s[80:81], s82
  v_readlane_b32 s83, v103, s82
  s_add_u32 s84, s86, s82
  s_mul_i32 s84, s84, 129024
  s_lshr_b32 s85, s83, 16
  s_and_b32 s83, s83, 0xffff
  s_add_u32 s83, s83, 16
L_iw0_long_win:
  v_add_u32 v106, s83, v1
  v_cmp_gt_u32 vcc, s85, v106
  v_mul_u32_u24 v106, 12, v106
  s_nop 0
  v_cndmask_b32 v106, v101, v106, vcc
  buffer_load_dwordx3 v[16:18], v106, s[12:15], s84 offen
  s_waitcnt vmcnt(0)
  v_cmp_gt_i32 s[64:65], 0, v16
  v_lshrrev_b32 v80, 22, v16
  v_and_or_b32 v80, v80, s52, v96
  v_cmp_gt_i32 s[66:67], 0, v17
  v_lshrrev_b32 v81, 22, v17
  v_and_or_b32 v81, v81, s52, v96
  s_mov_b64 exec, s[64:65]
  ds_add_rtn_u32 v88, v80, v97
  s_mov_b64 exec, s[66:67]
  ds_add_rtn_u32 v89, v81, v97
  s_mov_b64 exec, -1
  s_waitcnt lgkmcnt(0)
  s_mov_b64 exec, s[64:65]
  v_cmp_lt_u32 vcc, 127, v88
  v_min_u32 v88, 127, v88
  v_mad_u32_u24 v80, v80, v108, s53
  s_or_b64 s[54:55], s[54:55], vcc
  v_lshl_add_u32 v80, v88, 2, v80
  ds_write_b32 v80, v16 offset:42240
  v_lshrrev_b32 v88, 1, v80
  ds_write_b16 v88, v18
  s_mov_b64 exec, s[66:67]
  v_cmp_lt_u32 vcc, 127, v89
  v_min_u32 v89, 127, v89
  v_mad_u32_u24 v81, v81, v108, s53
  s_or_b64 s[54:55], s[54:55], vcc
  v_lshl_add_u32 v81, v89, 2, v81
  ds_write_b32 v81, v17 offset:42240
  v_lshrrev_b32 v89, 1, v81
  ds_write_b16_d16_hi v89, v18
  s_mov_b64 exec, -1
  s_add_u32 s83, s83, 64
  s_cmp_lt_u32 s83, s85
  s_cbranch_scc1 L_iw0_long_win
  s_branch L_iw0_long
L_iw0_long_done:
  s_cmp_eq_u64 s[54:55], 0
  s_cbranch_scc1 L_iw0_noovf
  ds_write_b32 v109, v97 offset:0
L_iw0_noovf:
  s_waitcnt lgkmcnt(0)
  s_mov_b64 exec, 1
  ds_add_u32 v109, v97 offset:4
  s_mov_b64 exec, -1
  s_add_u32 s62, s61, 2
  s_cmp_ge_u32 s62, 8
  s_cbranch_scc1 L_iw0_noraw
  s_waitcnt vmcnt(0)
  s_add_u32 s57, s61, 2
  s_and_b32 s57, s57, 1
  s_mul_i32 s57, s57, 250
  s_add_u32 s57, s57, s60
  s_mul_i32 s57, s57, 129024
  ds_bpermute_b32 v16, v98, v105 offset:0
  ds_bpermute_b32 v20, v98, v105 offset:16
  ds_bpermute_b32 v24, v98, v105 offset:32
  ds_bpermute_b32 v28, v98, v105 offset:48
  ds_bpermute_b32 v32, v98, v105 offset:64
  ds_bpermute_b32 v36, v98, v105 offset:80
  ds_bpermute_b32 v40, v98, v105 offset:96
  ds_bpermute_b32 v44, v98, v105 offset:112
  s_waitcnt lgkmcnt(7)
  v_and_b32 v106, 0xffff, v16
  v_lshrrev_b32 v107, 16, v16
  v_add_u32 v106, v106, v99
  v_cmp_lt_u32 vcc, v106, v107
  v_mad_u32_u24 v106, v106, 12, v100
  s_nop 0
  v_cndmask_b32 v106, v101, v106, vcc
  buffer_load_dwordx3 v[16:18], v106, s[12:15], s57 offen
  s_add_u32 s57, s57, 516096
  s_waitcnt lgkmcnt(6)
  v_and_b32 v106, 0xffff, v20
  v_lshrrev_b32 v107, 16, v20
  v_add_u32 v106, v106, v99
  v_cmp_lt_u32 vcc, v106, v107
  v_mad_u32_u24 v106, v106, 12, v100
  s_nop 0
  v_cndmask_b32 v106, v101, v106, vcc
  buffer_load_dwordx3 v[20:22], v106, s[12:15], s57 offen
  s_add_u32 s57, s57, 516096
  s_waitcnt lgkmcnt(5)
  v_and_b32 v106, 0xffff, v24
  v_lshrrev_b32 v107, 16, v24
  v_add_u32 v106, v106, v99
  v_cmp_lt_u32 vcc, v106, v107
  v_mad_u32_u24 v106, v106, 12, v100
  s_nop 0
  v_cndmask_b32 v106, v101, v106, vcc
  buffer_load_dwordx3 v[24:26], v106, s[12:15], s57 offen
  s_add_u32 s57, s57, 516096
  s_waitcnt lgkmcnt(4)
  v_and_b32 v106, 0xffff, v28
  v_lshrrev_b32 v107, 16, v28
  v_add_u32 v106, v106, v99
  v_cmp_lt_u32 vcc, v106, v107
  v_mad_u32_u24 v106, v106, 12, v100
  s_nop 0
  v_cndmask_b32 v106, v101, v106, vcc
  buffer_load_dwordx3 v[28:30], v106, s[12:15], s57 offen
  s_add_u32 s57, s57, 516096
  s_waitcnt lgkmcnt(3)
  v_and_b32 v106, 0xffff, v32
  v_lshrrev_b32 v107, 16, v32
  v_add_u32 v106, v106, v99
  v_cmp_lt_u32 vcc, v106, v107
  v_mad_u32_u24 v106, v106, 12, v100
  s_nop 0
  v_cndmask_b32 v106, v101, v106, vcc
  buffer_load_dwordx3 v[32:34], v106, s[12:15], s57 offen
  s_add_u32 s57, s57, 516096
  s_waitcnt lgkmcnt(2)
  v_and_b32 v106, 0xffff, v36
  v_lshrrev_b32 v107, 16, v36
  v_add_u32 v106, v106, v99
  v_cmp_lt_u32 vcc, v106, v107
  v_mad_u32_u24 v106, v106, 12, v100
  s_nop 0
  v_cndmask_b32 v106, v101, v106, vcc
  buffer_load_dwordx3 v[36:38], v106, s[12:15], s57 offen
  s_add_u32 s57, s57, 516096
  s_waitcnt lgkmcnt(1)
  v_and_b32 v106, 0xffff, v40
  v_lshrrev_b32 v107, 16, v40
  v_add_u32 v106, v106, v99
  v_cmp_lt_u32 vcc, v106, v107
  v_mad_u32_u24 v106, v106, 12, v100
  s_nop 0
  v_cndmask_b32 v106, v101, v106, vcc
  buffer_load_dwordx3 v[40:42], v106, s[12:15], s57 offen
  s_add_u32 s57, s57, 516096
  s_waitcnt lgkmcnt(0)
  v_and_b32 v106, 0xffff, v44
  v_lshrrev_b32 v107, 16, v44
  v_add_u32 v106, v106, v99
  v_cmp_lt_u32 vcc, v106, v107
  v_mad_u32_u24 v106, v106, 12, v100
  s_nop 0
  v_cndmask_b32 v106, v101, v106, vcc
  buffer_load_dwordx3 v[44:46], v106, s[12:15], s57 offen
  s_add_u32 s62, s61, 3
  s_cmp_ge_u32 s62, 8
  v_mov_b32 v103, v104
  v_mov_b32 v104, v105
  s_cbranch_scc1 L_iw0_nodesc
  s_add_u32 s59, s61, 3
  s_lshr_b32 s58, s59, 1
  s_add_u32 s58, s58, s2
  s_and_b32 s58, s58, 3
  s_lshl_b32 s58, s58, 8
  s_add_u32 s58, s58, s3
  s_lshl_b32 s58, s58, 9
  s_and_b32 s59, s59, 1
  s_mul_i32 s59, s59, 250
  s_add_u32 s59, s59, s60
  s_add_u32 s58, s58, s59
  s_lshl_b32 s58, s58, 2
  buffer_load_dword v105, v102, s[16:19], s58 offen
  s_branch L_iw0_nodesc
L_iw0_noraw:
  s_waitcnt vmcnt(0)
  v_mov_b32 v103, v104
L_iw0_nodesc:
  s_add_u32 s61, s61, 1
  s_lshr_b32 s87, s61, 1
  s_mul_i32 s87, s87, 8
L_iw1_poll:
  ds_read_b32 v106, v109 offset:16
  s_waitcnt lgkmcnt(0)
  v_readfirstlane_b32 s88, v106
  s_nop 3
  s_cmp_ge_u32 s88, s87
  s_cbranch_scc1 L_iw1_poll_ok
  s_sleep 24
  s_branch L_iw1_poll
L_iw1_poll_ok:
  v_mov_b32 v96, 137728
  s_mov_b32 s53, 0xfeeb3d00
  s_waitcnt vmcnt(9)
  v_cmp_gt_i32 s[64:65], 0, v48
  v_lshrrev_b32 v80, 22, v48
  v_and_or_b32 v80, v80, s52, v96
  v_cmp_gt_i32 s[66:67], 0, v49
  v_lshrrev_b32 v81, 22, v49
  v_and_or_b32 v81, v81, s52, v96
  s_mov_b64 exec, s[64:65]
  ds_add_rtn_u32 v88, v80, v97
  s_mov_b64 exec, s[66:67]
  ds_add_rtn_u32 v89, v81, v97
  s_mov_b64 exec, -1
  v_cmp_gt_i32 s[68:69], 0, v52
  v_lshrrev_b32 v82, 22, v52
  v_and_or_b32 v82, v82, s52, v96
  v_cmp_gt_i32 s[70:71], 0, v53
  v_lshrrev_b32 v83, 22, v53
  v_and_or_b32 v83, v83, s52, v96
  s_mov_b64 exec, s[68:69]
  ds_add_rtn_u32 v90, v82, v97
  s_mov_b64 exec, s[70:71]
  ds_add_rtn_u32 v91, v83, v97
  s_mov_b64 exec, -1
  v_cmp_gt_i32 s[72:73], 0, v56
  v_lshrrev_b32 v84, 22, v56
  v_and_or_b32 v84, v84, s52, v96
  v_cmp_gt_i32 s[74:75], 0, v57
  v_lshrrev_b32 v85, 22, v57
  v_and_or_b32 v85, v85, s52, v96
  s_mov_b64 exec, s[72:73]
  ds_add_rtn_u32 v92, v84, v97
  s_mov_b64 exec, s[74:75]
  ds_add_rtn_u32 v93, v85, v97
  s_mov_b64 exec, -1
  v_cmp_gt_i32 s[76:77], 0, v60
  v_lshrrev_b32 v86, 22, v60
  v_and_or_b32 v86, v86, s52, v96
  v_cmp_gt_i32 s[78:79], 0, v61
  v_lshrrev_b32 v87, 22, v61
  v_and_or_b32 v87, v87, s52, v96
  s_mov_b64 exec, s[76:77]
  ds_add_rtn_u32 v94, v86, v97
  s_mov_b64 exec, s[78:79]
  ds_add_rtn_u32 v95, v87, v97
  s_mov_b64 exec, -1
  s_waitcnt lgkmcnt(6)
  s_mov_b64 exec, s[64:65]
  v_cmp_lt_u32 vcc, 127, v88
  v_min_u32 v88, 127, v88
  v_mad_u32_u24 v80, v80, v108, s53
  s_or_b64 s[54:55], s[54:55], vcc
  v_lshl_add_u32 v80, v88, 2, v80
  ds_write_b32 v80, v48 offset:42240
  v_lshrrev_b32 v88, 1, v80
  ds_write_b16 v88, v50
  s_mov_b64 exec, s[66:67]
  v_cmp_lt_u32 vcc, 127, v89
  v_min_u32 v89, 127, v89
  v_mad_u32_u24 v81, v81, v108, s53
  s_or_b64 s[54:55], s[54:55], vcc
  v_lshl_add_u32 v81, v89, 2, v81
  ds_write_b32 v81, v49 offset:42240
  v_lshrrev_b32 v89, 1, v81
  ds_write_b16_d16_hi v89, v50
  s_mov_b64 exec, -1
  v_cmp_gt_i32 s[64:65], 0, v64
  v_lshrrev_b32 v80, 22, v64
  v_and_or_b32 v80, v80, s52, v96
  v_cmp_gt_i32 s[66:67], 0, v65
  v_lshrrev_b32 v81, 22, v65
  v_and_or_b32 v81, v81, s52, v96
  s_mov_b64 exec, s[64:65]
  ds_add_rtn_u32 v88, v80, v97
  s_mov_b64 exec, s[66:67]
  ds_add_rtn_u32 v89, v81, v97
  s_mov_b64 exec, -1
  s_waitcnt lgkmcnt(10)
  s_mov_b64 exec, s[68:69]
  v_cmp_lt_u32 vcc, 127, v90
  v_min_u32 v90, 127, v90
  v_mad_u32_u24 v82, v82, v108, s53
  s_or_b64 s[54:55], s[54:55], vcc
  v_lshl_add_u32 v82, v90, 2, v82
  ds_write_b32 v82, v52 offset:42240
  v_lshrrev_b32 v90, 1, v82
  ds_write_b16 v90, v54
  s_mov_b64 exec, s[70:71]
  v_cmp_lt_u32 vcc, 127, v91
  v_min_u32 v91, 127, v91
  v_mad_u32_u24 v83, v83, v108, s53
  s_or_b64 s[54:55], s[54:55], vcc
  v_lshl_add_u32 v83, v91, 2, v83
  ds_write_b32 v83, v53 offset:42240
  v_lshrrev_b32 v91, 1, v83
  ds_write_b16_d16_hi v91, v54
  s_mov_b64 exec, -1
  v_cmp_gt_i32 s[68:69], 0, v68
  v_lshrrev_b32 v82, 22, v68
  v_and_or_b32 v82, v82, s52, v96
  v_cmp_gt_i32 s[70:71], 0, v69
  v_lshrrev_b32 v83, 22, v69
  v_and_or_b32 v83, v83, s52, v96
  s_mov_b64 exec, s[68:69]
  ds_add_rtn_u32 v90, v82, v97
  s_mov_b64 exec, s[70:71]
  ds_add_rtn_u32 v91, v83, v97
  s_mov_b64 exec, -1
  s_waitcnt lgkmcnt(14)
  s_mov_b64 exec, s[72:73]
  v_cmp_lt_u32 vcc, 127, v92
  v_min_u32 v92, 127, v92
  v_mad_u32_u24 v84, v84, v108, s53
  s_or_b64 s[54:55], s[54:55], vcc
  v_lshl_add_u32 v84, v92, 2, v84
  ds_write_b32 v84, v56 offset:42240
  v_lshrrev_b32 v92, 1, v84
  ds_write_b16 v92, v58
  s_mov_b64 exec, s[74:75]
  v_cmp_lt_u32 vcc, 127, v93
  v_min_u32 v93, 127, v93
  v_mad_u32_u24 v85, v85, v108, s53
  s_or_b64 s[54:55], s[54:55], vcc
  v_lshl_add_u32 v85, v93, 2, v85
  ds_write_b32 v85, v57 offset:42240
  v_lshrrev_b32 v93, 1, v85
  ds_write_b16_d16_hi v93, v58
  s_mov_b64 exec, -1
  v_cmp_gt_i32 s[72:73], 0, v72
  v_lshrrev_b32 v84, 22, v72
  v_and_or_b32 v84, v84, s52, v96
  v_cmp_gt_i32 s[74:75], 0, v73
  v_lshrrev_b32 v85, 22, v73
  v_and_or_b32 v85, v85, s52, v96
  s_mov_b64 exec, s[72:73]
  ds_add_rtn_u32 v92, v84, v97
  s_mov_b64 exec, s[74:75]
  ds_add_rtn_u32 v93, v85, v97
  s_mov_b64 exec, -1
  s_waitcnt lgkmcnt(15)
  s_mov_b64 exec, s[76:77]
  v_cmp_lt_u32 vcc, 127, v94
  v_min_u32 v94, 127, v94
  v_mad_u32_u24 v86, v86, v108, s53
  s_or_b64 s[54:55], s[54:55], vcc
  v_lshl_add_u32 v86, v94, 2, v86
  ds_write_b32 v86, v60 offset:42240
  v_lshrrev_b32 v94, 1, v86
  ds_write_b16 v94, v62
  s_mov_b64 exec, s[78:79]
  v_cmp_lt_u32 vcc, 127, v95
  v_min_u32 v95, 127, v95
  v_mad_u32_u24 v87, v87, v108, s53
  s_or_b64 s[54:55], s[54:55], vcc
  v_lshl_add_u32 v87, v95, 2, v87
  ds_write_b32 v87, v61 offset:42240
  v_lshrrev_b32 v95, 1, v87
  ds_write_b16_d16_hi v95, v62
  s_mov_b64 exec, -1
  v_cmp_gt_i32 s[76:77], 0, v76
  v_lshrrev_b32 v86, 22, v76
  v_and_or_b32 v86, v86, s52, v96
  v_cmp_gt_i32 s[78:79], 0, v77
  v_lshrrev_b32 v87, 22, v77
  v_and_or_b32 v87, v87, s52, v96
  s_mov_b64 exec, s[76:77]
  ds_add_rtn_u32 v94, v86, v97
  s_mov_b64 exec, s[78:79]
  ds_add_rtn_u32 v95, v87, v97
  s_mov_b64 exec, -1
  s_waitcnt lgkmcnt(15)
  s_mov_b64 exec, s[64:65]
  v_cmp_lt_u32 vcc, 127, v88
  v_min_u32 v88, 127, v88
  v_mad_u32_u24 v80, v80, v108, s53
  s_or_b64 s[54:55], s[54:55], vcc
  v_lshl_add_u32 v80, v88, 2, v80
  ds_write_b32 v80, v64 offset:42240
  v_lshrrev_b32 v88, 1, v80
  ds_write_b16 v88, v66
  s_mov_b64 exec, s[66:67]
  v_cmp_lt_u32 vcc, 127, v89
  v_min_u32 v89, 127, v89
  v_mad_u32_u24 v81, v81, v108, s53
  s_or_b64 s[54:55], s[54:55], vcc
  v_lshl_add_u32 v81, v89, 2, v81
  ds_write_b32 v81, v65 offset:42240
  v_lshrrev_b32 v89, 1, v81
  ds_write_b16_d16_hi v89, v66
  s_mov_b64 exec, -1
  s_waitcnt lgkmcnt(15)
  s_mov_b64 exec, s[68:69]
  v_cmp_lt_u32 vcc, 127, v90
  v_min_u32 v90, 127, v90
  v_mad_u32_u24 v82, v82, v108, s53
  s_or_b64 s[54:55], s[54:55], vcc
  v_lshl_add_u32 v82, v90, 2, v82
  ds_write_b32 v82, v68 offset:42240
  v_lshrrev_b32 v90, 1, v82
  ds_write_b16 v90, v70
  s_mov_b64 exec, s[70:71]
  v_cmp_lt_u32 vcc, 127, v91
  v_min_u32 v91, 127, v91
  v_mad_u32_u24 v83, v83, v108, s53
  s_or_b64 s[54:55], s[54:55], vcc
  v_lshl_add_u32 v83, v91, 2, v83
  ds_write_b32 v83, v69 offset:42240
  v_lshrrev_b32 v91, 1, v83
  ds_write_b16_d16_hi v91, v70
  s_mov_b64 exec, -1
  s_waitcnt lgkmcnt(14)
  s_mov_b64 exec, s[72:73]
  v_cmp_lt_u32 vcc, 127, v92
  v_min_u32 v92, 127, v92
  v_mad_u32_u24 v84, v84, v108, s53
  s_or_b64 s[54:55], s[54:55], vcc
  v_lshl_add_u32 v84, v92, 2, v84
  ds_write_b32 v84, v72 offset:42240
  v_lshrrev_b32 v92, 1, v84
  ds_write_b16 v92, v74
  s_mov_b64 exec, s[74:75]
  v_cmp_lt_u32 vcc, 127, v93
  v_min_u32 v93, 127, v93
  v_mad_u32_u24 v85, v85, v108, s53
  s_or_b64 s[54:55], s[54:55], vcc
  v_lshl_add_u32 v85, v93, 2, v85
  ds_write_b32 v85, v73 offset:42240
  v_lshrrev_b32 v93, 1, v85
  ds_write_b16_d16_hi v93, v74
  s_mov_b64 exec, -1
  s_waitcnt lgkmcnt(12)
  s_mov_b64 exec, s[76:77]
  v_cmp_lt_u32 vcc, 127, v94
  v_min_u32 v94, 127, v94
  v_mad_u32_u24 v86, v86, v108, s53
  s_or_b64 s[54:55], s[54:55], vcc
  v_lshl_add_u32 v86, v94, 2, v86
  ds_write_b32 v86, v76 offset:42240
  v_lshrrev_b32 v94, 1, v86
  ds_write_b16 v94, v78
  s_mov_b64 exec, s[78:79]
  v_cmp_lt_u32 vcc, 127, v95
  v_min_u32 v95, 127, v95
  v_mad_u32_u24 v87, v87, v108, s53
  s_or_b64 s[54:55], s[54:55], vcc
  v_lshl_add_u32 v87, v95, 2, v87
  ds_write_b32 v87, v77 offset:42240
  v_lshrrev_b32 v95, 1, v87
  ds_write_b16_d16_hi v95, v78
  s_mov_b64 exec, -1
  v_and_b32 v106, 0xffff, v103
  v_lshrrev_b32 v107, 16, v103
  v_add_u32 v106, 16, v106
  v_cmp_lt_u32 s[80:81], v106, v107
  s_add_u32 s86, s61, 0
  s_and_b32 s86, s86, 1
  s_mul_i32 s86, s86, 250
  s_add_u32 s86, s86, s60
L_iw1_long:
  s_cmp_eq_u64 s[80:81], 0
  s_cbranch_scc1 L_iw1_long_done
  s_ff1_i32_b64 s82, s[80:81]
  s_bitset0_b64 s[80:81], s82
  v_readlane_b32 s83, v103, s82
  s_add_u32 s84, s86, s82
  s_mul_i32 s84, s84, 129024
  s_lshr_b32 s85, s83, 16
  s_and_b32 s83, s83, 0xffff
  s_add_u32 s83, s83, 16
L_iw1_long_win:
  v_add_u32 v106, s83, v1
  v_cmp_gt_u32 vcc, s85, v106
  v_mul_u32_u24 v106, 12, v106
  s_nop 0
  v_cndmask_b32 v106, v101, v106, vcc
  buffer_load_dwordx3 v[48:50], v106, s[12:15], s84 offen
  s_waitcnt vmcnt(0)
  v_cmp_gt_i32 s[64:65], 0, v48
  v_lshrrev_b32 v80, 22, v48
  v_and_or_b32 v80, v80, s52, v96
  v_cmp_gt_i32 s[66:67], 0, v49
  v_lshrrev_b32 v81, 22, v49
  v_and_or_b32 v81, v81, s52, v96
  s_mov_b64 exec, s[64:65]
  ds_add_rtn_u32 v88, v80, v97
  s_mov_b64 exec, s[66:67]
  ds_add_rtn_u32 v89, v81, v97
  s_mov_b64 exec, -1
  s_waitcnt lgkmcnt(0)
  s_mov_b64 exec, s[64:65]
  v_cmp_lt_u32 vcc, 127, v88
  v_min_u32 v88, 127, v88
  v_mad_u32_u24 v80, v80, v108, s53
  s_or_b64 s[54:55], s[54:55], vcc
  v_lshl_add_u32 v80, v88, 2, v80
  ds_write_b32 v80, v48 offset:42240
  v_lshrrev_b32 v88, 1, v80
  ds_write_b16 v88, v50
  s_mov_b64 exec, s[66:67]
  v_cmp_lt_u32 vcc, 127, v89
  v_min_u32 v89, 127, v89
  v_mad_u32_u24 v81, v81, v108, s53
  s_or_b64 s[54:55], s[54:55], vcc
  v_lshl_add_u32 v81, v89, 2, v81
  ds_write_b32 v81, v49 offset:42240
  v_lshrrev_b32 v89, 1, v81
  ds_write_b16_d16_hi v89, v50
  s_mov_b64 exec, -1
  s_add_u32 s83, s83, 64
  s_cmp_lt_u32 s83, s85
  s_cbranch_scc1 L_iw1_long_win
  s_branch L_iw1_long
L_iw1_long_done:
  s_cmp_eq_u64 s[54:55], 0
  s_cbranch_scc1 L_iw1_noovf
  ds_write_b32 v109, v97 offset:0
L_iw1_noovf:
  s_waitcnt lgkmcnt(0)
  s_mov_b64 exec, 1
  ds_add_u32 v109, v97 offset:8
  s_mov_b64 exec, -1
  s_add_u32 s62, s61, 2
  s_cmp_ge_u32 s62, 8
  s_cbranch_scc1 L_iw1_noraw
  s_waitcnt vmcnt(0)
  s_add_u32 s57, s61, 2
  s_and_b32 s57, s57, 1
  s_mul_i32 s57, s57, 250
  s_add_u32 s57, s57, s60
  s_mul_i32 s57, s57, 129024
  ds_bpermute_b32 v48, v98, v105 offset:0
  ds_bpermute_b32 v52, v98, v105 offset:16
  ds_bpermute_b32 v56, v98, v105 offset:32
  ds_bpermute_b32 v60, v98, v105 offset:48
  ds_bpermute_b32 v64, v98, v105 offset:64
  ds_bpermute_b32 v68, v98, v105 offset:80
  ds_bpermute_b32 v72, v98, v105 offset:96
  ds_bpermute_b32 v76, v98, v105 offset:112
  s_waitcnt lgkmcnt(7)
  v_and_b32 v106, 0xffff, v48
  v_lshrrev_b32 v107, 16, v48
  v_add_u32 v106, v106, v99
  v_cmp_lt_u32 vcc, v106, v107
  v_mad_u32_u24 v106, v106, 12, v100
  s_nop 0
  v_cndmask_b32 v106, v101, v106, vcc
  buffer_load_dwordx3 v[48:50], v106, s[12:15], s57 offen
  s_add_u32 s57, s57, 516096
  s_waitcnt lgkmcnt(6)
  v_and_b32 v106, 0xffff, v52
  v_lshrrev_b32 v107, 16, v52
  v_add_u32 v106, v106, v99
  v_cmp_lt_u32 vcc, v106, v107
  v_mad_u32_u24 v106, v106, 12, v100
  s_nop 0
  v_cndmask_b32 v106, v101, v106, vcc
  buffer_load_dwordx3 v[52:54], v106, s[12:15], s57 offen
  s_add_u32 s57, s57, 516096
  s_waitcnt lgkmcnt(5)
  v_and_b32 v106, 0xffff, v56
  v_lshrrev_b32 v107, 16, v56
  v_add_u32 v106, v106, v99
  v_cmp_lt_u32 vcc, v106, v107
  v_mad_u32_u24 v106, v106, 12, v100
  s_nop 0
  v_cndmask_b32 v106, v101, v106, vcc
  buffer_load_dwordx3 v[56:58], v106, s[12:15], s57 offen
  s_add_u32 s57, s57, 516096
  s_waitcnt lgkmcnt(4)
  v_and_b32 v106, 0xffff, v60
  v_lshrrev_b32 v107, 16, v60
  v_add_u32 v106, v106, v99
  v_cmp_lt_u32 vcc, v106, v107
  v_mad_u32_u24 v106, v106, 12, v100
  s_nop 0
  v_cndmask_b32 v106, v101, v106, vcc
  buffer_load_dwordx3 v[60:62], v106, s[12:15], s57 offen
  s_add_u32 s57, s57, 516096
  s_waitcnt lgkmcnt(3)
  v_and_b32 v106, 0xffff, v64
  v_lshrrev_b32 v107, 16, v64
  v_add_u32 v106, v106, v99
  v_cmp_lt_u32 vcc, v106, v107
  v_mad_u32_u24 v106, v106, 12, v100
  s_nop 0
  v_cndmask_b32 v106, v101, v106, vcc
  buffer_load_dwordx3 v[64:66], v106, s[12:15], s57 offen
  s_add_u32 s57, s57, 516096
  s_waitcnt lgkmcnt(2)
  v_and_b32 v106, 0xffff, v68
  v_lshrrev_b32 v107, 16, v68
  v_add_u32 v106, v106, v99
  v_cmp_lt_u32 vcc, v106, v107
  v_mad_u32_u24 v106, v106, 12, v100
  s_nop 0
  v_cndmask_b32 v106, v101, v106, vcc
  buffer_load_dwordx3 v[68:70], v106, s[12:15], s57 offen
  s_add_u32 s57, s57, 516096
  s_waitcnt lgkmcnt(1)
  v_and_b32 v106, 0xffff, v72
  v_lshrrev_b32 v107, 16, v72
  v_add_u32 v106, v106, v99
  v_cmp_lt_u32 vcc, v106, v107
  v_mad_u32_u24 v106, v106, 12, v100
  s_nop 0
  v_cndmask_b32 v106, v101, v106, vcc
  buffer_load_dwordx3 v[72:74], v106, s[12:15], s57 offen
  s_add_u32 s57, s57, 516096
  s_waitcnt lgkmcnt(0)
  v_and_b32 v106, 0xffff, v76
  v_lshrrev_b32 v107, 16, v76
  v_add_u32 v106, v106, v99
  v_cmp_lt_u32 vcc, v106, v107
  v_mad_u32_u24 v106, v106, 12, v100
  s_nop 0
  v_cndmask_b32 v106, v101, v106, vcc
  buffer_load_dwordx3 v[76:78], v106, s[12:15], s57 offen
  s_add_u32 s62, s61, 3
  s_cmp_ge_u32 s62, 8
  v_mov_b32 v103, v104
  v_mov_b32 v104, v105
  s_cbranch_scc1 L_iw1_nodesc
  s_add_u32 s59, s61, 3
  s_lshr_b32 s58, s59, 1
  s_add_u32 s58, s58, s2
  s_and_b32 s58, s58, 3
  s_lshl_b32 s58, s58, 8
  s_add_u32 s58, s58, s3
  s_lshl_b32 s58, s58, 9
  s_and_b32 s59, s59, 1
  s_mul_i32 s59, s59, 250
  s_add_u32 s59, s59, s60
  s_add_u32 s58, s58, s59
  s_lshl_b32 s58, s58, 2
  buffer_load_dword v105, v102, s[16:19], s58 offen
  s_branch L_iw1_nodesc
L_iw1_noraw:
  s_waitcnt vmcnt(0)
  v_mov_b32 v103, v104
L_iw1_nodesc:
  s_add_u32 s61, s61, 1
  s_cmp_lt_u32 s61, 8
  s_cbranch_scc1 L_iw_loop
  s_mov_b32 s87, 32
L_sl_w:
  ds_read_b32 v106, v109 offset:8
  s_waitcnt lgkmcnt(0)
  v_readfirstlane_b32 s88, v106
  s_nop 3
  s_cmp_ge_u32 s88, s87
  s_cbranch_scc1 L_sl_w_ok
  s_sleep 2
  s_branch L_sl_w
L_sl_w_ok:
  ds_read_b32 v106, v109 offset:0
  s_waitcnt lgkmcnt(0)
  v_readfirstlane_b32 s88, v106
  s_nop 3
  s_cmp_eq_u32 s88, 0
  s_cbranch_scc1 L_iw_epi
  s_setprio 0
  s_mov_b32 s62, 0
L_sl_q:
  s_add_u32 s59, s62, 0
  s_lshr_b32 s58, s59, 1
  s_add_u32 s58, s58, s2
  s_and_b32 s58, s58, 3
  s_lshl_b32 s58, s58, 8
  s_add_u32 s58, s58, s3
  s_lshl_b32 s58, s58, 9
  s_and_b32 s59, s59, 1
  s_mul_i32 s59, s59, 250
  s_add_u32 s59, s59, s60
  s_add_u32 s58, s58, s59
  s_lshl_b32 s58, s58, 2
  buffer_load_dword v103, v102, s[16:19], s58 offen
  s_add_u32 s86, s62, 0
  s_and_b32 s86, s86, 1
  s_mul_i32 s86, s86, 250
  s_add_u32 s86, s86, s60
  s_mov_b32 s82, 0
  s_waitcnt vmcnt(0)
L_sl_tile:
  v_readlane_b32 s83, v103, s82
  s_add_u32 s84, s86, s82
  s_mul_i32 s84, s84, 129024
  s_lshr_b32 s85, s83, 16
  s_and_b32 s83, s83, 0xffff
L_sl_win:
  s_cmp_ge_u32 s83, s85
  s_cbranch_scc1 L_sl_next
  s_and_b32 s88, s61, 1
  s_cmp_eq_u32 s88, 0
  s_mov_b32 s53, 0xfeeba000
  s_mov_b32 s89, 0xfeeb3d00
  s_cselect_b32 s53, s53, s89
  s_lshl_b32 s89, s88, 9
  s_add_u32 s89, s89, 137216
  v_mov_b32 v96, s89
  s_lshl_b32 s89, s88, 2
  v_add_u32 v107, s89, v109
  s_lshr_b32 s87, s61, 1
  s_mul_i32 s87, s87, 8
L_sl_d:
  ds_read_b32 v106, v107 offset:12
  s_waitcnt lgkmcnt(0)
  v_readfirstlane_b32 s88, v106
  s_nop 3
  s_cmp_ge_u32 s88, s87
  s_cbranch_scc1 L_sl_d_ok
  s_sleep 2
  s_branch L_sl_d
L_sl_d_ok:
  v_add_u32 v106, s83, v1
  v_cmp_gt_u32 vcc, s85, v106
  v_cmp_gt_u32 s[80:81], 8, v1
  v_mul_u32_u24 v106, 12, v106
  s_and_b64 vcc, vcc, s[80:81]
  s_nop 1
  v_cndmask_b32 v106, v101, v106, vcc
  buffer_load_dwordx3 v[16:18], v106, s[12:15], s84 offen
  s_waitcnt vmcnt(0)
  v_cmp_gt_i32 s[64:65], 0, v16
  v_lshrrev_b32 v80, 22, v16
  v_and_or_b32 v80, v80, s52, v96
  v_cmp_gt_i32 s[66:67], 0, v17
  v_lshrrev_b32 v81, 22, v17
  v_and_or_b32 v81, v81, s52, v96
  s_mov_b64 exec, s[64:65]
  ds_add_rtn_u32 v88, v80, v97
  s_mov_b64 exec, s[66:67]
  ds_add_rtn_u32 v89, v81, v97
  s_mov_b64 exec, -1
  s_waitcnt lgkmcnt(0)
  s_mov_b64 exec, s[64:65]
  v_cmp_lt_u32 vcc, 127, v88
  v_min_u32 v88, 127, v88
  v_mad_u32_u24 v80, v80, v108, s53
  s_or_b64 s[54:55], s[54:55], vcc
  v_lshl_add_u32 v80, v88, 2, v80
  ds_write_b32 v80, v16 offset:42240
  v_lshrrev_b32 v88, 1, v80
  ds_write_b16 v88, v18
  s_mov_b64 exec, s[66:67]
  v_cmp_lt_u32 vcc, 127, v89
  v_min_u32 v89, 127, v89
  v_mad_u32_u24 v81, v81, v108, s53
  s_or_b64 s[54:55], s[54:55], vcc
  v_lshl_add_u32 v81, v89, 2, v81
  ds_write_b32 v81, v17 offset:42240
  v_lshrrev_b32 v89, 1, v81
  ds_write_b16_d16_hi v89, v18
  s_mov_b64 exec, -1
  s_waitcnt lgkmcnt(0)
  s_mov_b64 exec, 1
  ds_add_u32 v107, v97 offset:4
  s_mov_b64 exec, -1
  s_add_u32 s61, s61, 1
  s_add_u32 s83, s83, 8
  s_branch L_sl_win
L_sl_next:
  s_add_u32 s82, s82, 1
  s_cmp_lt_u32 s82, 32
  s_cbranch_scc1 L_sl_tile
  s_add_u32 s62, s62, 1
  s_cmp_lt_u32 s62, 8
  s_cbranch_scc1 L_sl_q
  s_mov_b32 s63, 1
L_sl_idle:
  ds_read_b32 v106, v109 offset:68
  s_waitcnt lgkmcnt(0)
  v_readfirstlane_b32 s88, v106
  s_nop 3
  s_cmp_eq_u32 s88, 0
  s_cbranch_scc1 L_sl_cont
  s_cmp_ge_u32 s61, s88
  s_cbranch_scc1 L_iw_epi
L_sl_cont:
  s_and_b32 s88, s61, 1
  s_cmp_eq_u32 s88, 0
  s_mov_b32 s53, 0xfeeba000
  s_mov_b32 s89, 0xfeeb3d00
  s_cselect_b32 s53, s53, s89
  s_lshl_b32 s89, s88, 9
  s_add_u32 s89, s89, 137216
  v_mov_b32 v96, s89
  s_lshl_b32 s89, s88, 2
  v_add_u32 v107, s89, v109
  s_lshr_b32 s87, s61, 1
  s_mul_i32 s87, s87, 8
  ds_read_b32 v106, v107 offset:12
  s_waitcnt lgkmcnt(0)
  v_readfirstlane_b32 s88, v106
  s_nop 3
  s_cmp_ge_u32 s88, s87
  s_cbranch_scc1 L_sl_go
  s_sleep 2
  s_branch L_sl_idle
L_sl_go:
  s_cmp_eq_u32 s63, 0
  s_cbranch_scc1 L_sl_sig
  s_mov_b32 s63, 0
  s_mov_b64 exec, 1
  ds_add_rtn_u32 v106, v109, v97 offset:64
  s_waitcnt lgkmcnt(0)
  v_readfirstlane_b32 s88, v106
  s_mov_b64 exec, -1
  s_nop 2
  s_cmp_lg_u32 s88, 7
  s_cbranch_scc1 L_sl_sig
  s_add_u32 s88, s61, 1
  v_mov_b32 v106, s88
  ds_write_b32 v109, v106 offset:68
  s_waitcnt lgkmcnt(0)
L_sl_sig:
  s_mov_b64 exec, 1
  ds_add_u32 v107, v97 offset:4
  s_mov_b64 exec, -1
  s_add_u32 s61, s61, 1
  s_branch L_sl_idle
L_iw_epi:
  s_load_dwordx2 s[36:37], s[0:1], 24
  s_load_dwordx2 s[38:39], s[0:1], 40
  s_load_dwordx4 s[40:43], s[0:1], 56
  s_load_dwordx4 s[44:47], s[0:1], 80
  s_waitcnt lgkmcnt(0)
  s_mov_b32 s12, s36
  s_mov_b32 s13, s37
  s_mov_b32 s14, 640000
  s_mov_b32 s15, 0x20000
  s_mov_b32 s16, s46
  s_mov_b32 s17, s47
  s_mov_b32 s18, 10240000
  s_mov_b32 s19, 0x20000
  s_mov_b32 s20, s38
  s_mov_b32 s21, s39
  s_mov_b32 s22, 16
  s_mov_b32 s23, 0x20000
  s_mov_b32 s24, s40
  s_mov_b32 s25, s41
  s_mov_b32 s26, 256
  s_mov_b32 s27, 0x20000
  s_mov_b32 s28, s42
  s_mov_b32 s29, s43
  s_mov_b32 s30, 256
  s_mov_b32 s31, 0x20000
  s_mov_b32 s48, s44
  s_mov_b32 s49, s45
  s_mov_b32 s50, 512
  s_mov_b32 s51, 0x20000
  v_and_b32 v2, 15, v1
  v_lshrrev_b32 v3, 4, v1
  v_lshlrev_b32 v4, 6, v3
  v_lshl_add_u32 v4, v2, 1, v4
  buffer_load_ushort v96, v4, s[28:31], 0 offen
  buffer_load_ushort v97, v4, s[28:31], 0 offen offset:32
  buffer_load_ushort v98, v4, s[24:27], 0 offen
  buffer_load_ushort v99, v4, s[24:27], 0 offen offset:32
  v_lshlrev_b32 v4, 7, v3
  v_lshl_add_u32 v4, v2, 1, v4
  buffer_load_ushort v100, v4, s[48:51], 0 offen offset:0
  buffer_load_ushort v101, v4, s[48:51], 0 offen offset:32
  buffer_load_ushort v102, v4, s[48:51], 0 offen offset:64
  buffer_load_ushort v103, v4, s[48:51], 0 offen offset:96
  v_lshlrev_b32 v4, 2, v3
  buffer_load_ushort v104, v4, s[20:23], 0 offen
  buffer_load_ushort v105, v4, s[20:23], 0 offen offset:2
  s_sub_u32 s52, s35, 8
  s_mul_i32 s52, s52, 160
  v_add_u32 v5, s52, v2
  s_mul_i32 s53, s3, 1250
  v_add_u32 v6, s53, v5
  v_lshlrev_b32 v7, 1, v6
  buffer_load_ushort v16, v7, s[12:15], 0 offen
  v_lshlrev_b32 v7, 5, v6
  v_lshl_add_u32 v7, v3, 3, v7
  buffer_load_dwordx2 v[22:23], v7, s[8:11], 0 offen
  v_add_u32 v6, s53, v5
  v_add_u32 v6, 16, v6
  v_lshlrev_b32 v7, 1, v6
  buffer_load_ushort v24, v7, s[12:15], 0 offen
  v_lshlrev_b32 v7, 5, v6
  v_lshl_add_u32 v7, v3, 3, v7
  buffer_load_dwordx2 v[30:31], v7, s[8:11], 0 offen
  v_add_u32 v6, s53, v5
  v_add_u32 v6, 32, v6
  v_lshlrev_b32 v7, 1, v6
  buffer_load_ushort v32, v7, s[12:15], 0 offen
  v_lshlrev_b32 v7, 5, v6
  v_lshl_add_u32 v7, v3, 3, v7
  buffer_load_dwordx2 v[38:39], v7, s[8:11], 0 offen
  v_add_u32 v6, s53, v5
  v_add_u32 v6, 48, v6
  v_lshlrev_b32 v7, 1, v6
  buffer_load_ushort v40, v7, s[12:15], 0 offen
  v_lshlrev_b32 v7, 5, v6
  v_lshl_add_u32 v7, v3, 3, v7
  buffer_load_dwordx2 v[46:47], v7, s[8:11], 0 offen
  v_add_u32 v6, s53, v5
  v_add_u32 v6, 64, v6
  v_lshlrev_b32 v7, 1, v6
  buffer_load_ushort v48, v7, s[12:15], 0 offen
  v_lshlrev_b32 v7, 5, v6
  v_lshl_add_u32 v7, v3, 3, v7
  buffer_load_dwordx2 v[54:55], v7, s[8:11], 0 offen
  v_add_u32 v6, s53, v5
  v_add_u32 v6, 80, v6
  v_lshlrev_b32 v7, 1, v6
  buffer_load_ushort v56, v7, s[12:15], 0 offen
  v_lshlrev_b32 v7, 5, v6
  v_lshl_add_u32 v7, v3, 3, v7
  buffer_load_dwordx2 v[62:63], v7, s[8:11], 0 offen
  v_add_u32 v6, s53, v5
  v_add_u32 v6, 96, v6
  v_lshlrev_b32 v7, 1, v6
  buffer_load_ushort v64, v7, s[12:15], 0 offen
  v_lshlrev_b32 v7, 5, v6
  v_lshl_add_u32 v7, v3, 3, v7
  buffer_load_dwordx2 v[70:71], v7, s[8:11], 0 offen
  v_add_u32 v6, s53, v5
  v_add_u32 v6, 112, v6
  v_lshlrev_b32 v7, 1, v6
  buffer_load_ushort v72, v7, s[12:15], 0 offen
  v_lshlrev_b32 v7, 5, v6
  v_lshl_add_u32 v7, v3, 3, v7
  buffer_load_dwordx2 v[78:79], v7, s[8:11], 0 offen
  v_add_u32 v6, s53, v5
  v_add_u32 v6, 128, v6
  v_lshlrev_b32 v7, 1, v6
  buffer_load_ushort v80, v7, s[12:15], 0 offen
  v_lshlrev_b32 v7, 5, v6
  v_lshl_add_u32 v7, v3, 3, v7
  buffer_load_dwordx2 v[86:87], v7, s[8:11], 0 offen
  v_add_u32 v6, s53, v5
  v_add_u32 v6, 144, v6
  v_lshlrev_b32 v7, 1, v6
  buffer_load_ushort v88, v7, s[12:15], 0 offen
  v_lshlrev_b32 v7, 5, v6
  v_lshl_add_u32 v7, v3, 3, v7
  buffer_load_dwordx2 v[94:95], v7, s[8:11], 0 offen
  s_waitcnt vmcnt(20)
  v_lshl_or_b32 v108, v97, 16, v96
  v_lshl_or_b32 v112, v99, 16, v98
  v_lshl_or_b32 v116, v101, 16, v100
  v_lshl_or_b32 v117, v103, 16, v102
  v_mov_b32 v118, v116
  v_mov_b32 v119, v117
  v_mov_b32 v109, 0
  v_mov_b32 v110, 0
  v_mov_b32 v111, 0
  v_mov_b32 v113, 0
  v_mov_b32 v114, 0
  v_mov_b32 v115, 0
  v_mov_b32 v121, 0
  v_mov_b32 v122, 0
  v_mov_b32 v123, 0
  v_lshlrev_b32 v104, 16, v104
  v_lshlrev_b32 v105, 16, v105
  s_mov_b32 s54, 0xffff0000
  s_mov_b32 s55, 0xc1200000
  s_mov_b32 s56, 0x3fb8aa3b
  s_waitcnt vmcnt(0)
  v_lshlrev_b32 v8, 16, v16
  v_sub_f32 v9, v8, v104
  v_sub_f32 v10, v8, v105
  v_cvt_pk_bf16_f32 v11, v9, v10
  v_lshlrev_b32 v9, 16, v11
  v_and_b32 v10, s54, v11
  v_mul_f32 v9, v9, v9
  v_mul_f32 v10, v10, v10
  v_cvt_pk_bf16_f32 v11, v9, v10
  v_lshlrev_b32 v9, 16, v11
  v_and_b32 v10, s54, v11
  v_mul_f32 v9, s55, v9
  v_mul_f32 v10, s55, v10
  v_cvt_pk_bf16_f32 v11, v9, v10
  v_lshlrev_b32 v9, 16, v11
  v_and_b32 v10, s54, v11
  v_mul_f32 v9, s56, v9
  v_mul_f32 v10, s56, v10
  v_exp_f32 v9, v9
  v_exp_f32 v10, v10
  s_nop 0
  v_cvt_pk_bf16_f32 v120, v9, v10
  s_nop 1
  v_mfma_f32_16x16x32_bf16 v[16:19], v[108:111], v[120:123], 0
  v_mfma_f32_16x16x32_bf16 v[96:99], v[112:115], v[120:123], 0
  s_nop 7
  v_cvt_pk_bf16_f32 v20, v96, v97
  v_cvt_pk_bf16_f32 v21, v98, v99
  v_lshlrev_b32 v8, 16, v24
  v_sub_f32 v9, v8, v104
  v_sub_f32 v10, v8, v105
  v_cvt_pk_bf16_f32 v11, v9, v10
  v_lshlrev_b32 v9, 16, v11
  v_and_b32 v10, s54, v11
  v_mul_f32 v9, v9, v9
  v_mul_f32 v10, v10, v10
  v_cvt_pk_bf16_f32 v11, v9, v10
  v_lshlrev_b32 v9, 16, v11
  v_and_b32 v10, s54, v11
  v_mul_f32 v9, s55, v9
  v_mul_f32 v10, s55, v10
  v_cvt_pk_bf16_f32 v11, v9, v10
  v_lshlrev_b32 v9, 16, v11
  v_and_b32 v10, s54, v11
  v_mul_f32 v9, s56, v9
  v_mul_f32 v10, s56, v10
  v_exp_f32 v9, v9
  v_exp_f32 v10, v10
  s_nop 0
  v_cvt_pk_bf16_f32 v120, v9, v10
  s_nop 1
  v_mfma_f32_16x16x32_bf16 v[24:27], v[108:111], v[120:123], 0
  v_mfma_f32_16x16x32_bf16 v[96:99], v[112:115], v[120:123], 0
  s_nop 7
  v_cvt_pk_bf16_f32 v28, v96, v97
  v_cvt_pk_bf16_f32 v29, v98, v99
  v_lshlrev_b32 v8, 16, v32
  v_sub_f32 v9, v8, v104
  v_sub_f32 v10, v8, v105
  v_cvt_pk_bf16_f32 v11, v9, v10
  v_lshlrev_b32 v9, 16, v11
  v_and_b32 v10, s54, v11
  v_mul_f32 v9, v9, v9
  v_mul_f32 v10, v10, v10
  v_cvt_pk_bf16_f32 v11, v9, v10
  v_lshlrev_b32 v9, 16, v11
  v_and_b32 v10, s54, v11
  v_mul_f32 v9, s55, v9
  v_mul_f32 v10, s55, v10
  v_cvt_pk_bf16_f32 v11, v9, v10
  v_lshlrev_b32 v9, 16, v11
  v_and_b32 v10, s54, v11
  v_mul_f32 v9, s56, v9
  v_mul_f32 v10, s56, v10
  v_exp_f32 v9, v9
  v_exp_f32 v10, v10
  s_nop 0
  v_cvt_pk_bf16_f32 v120, v9, v10
  s_nop 1
  v_mfma_f32_16x16x32_bf16 v[32:35], v[108:111], v[120:123], 0
  v_mfma_f32_16x16x32_bf16 v[96:99], v[112:115], v[120:123], 0
  s_nop 7
  v_cvt_pk_bf16_f32 v36, v96, v97
  v_cvt_pk_bf16_f32 v37, v98, v99
  v_lshlrev_b32 v8, 16, v40
  v_sub_f32 v9, v8, v104
  v_sub_f32 v10, v8, v105
  v_cvt_pk_bf16_f32 v11, v9, v10
  v_lshlrev_b32 v9, 16, v11
  v_and_b32 v10, s54, v11
  v_mul_f32 v9, v9, v9
  v_mul_f32 v10, v10, v10
  v_cvt_pk_bf16_f32 v11, v9, v10
  v_lshlrev_b32 v9, 16, v11
  v_and_b32 v10, s54, v11
  v_mul_f32 v9, s55, v9
  v_mul_f32 v10, s55, v10
  v_cvt_pk_bf16_f32 v11, v9, v10
  v_lshlrev_b32 v9, 16, v11
  v_and_b32 v10, s54, v11
  v_mul_f32 v9, s56, v9
  v_mul_f32 v10, s56, v10
  v_exp_f32 v9, v9
  v_exp_f32 v10, v10
  s_nop 0
  v_cvt_pk_bf16_f32 v120, v9, v10
  s_nop 1
  v_mfma_f32_16x16x32_bf16 v[40:43], v[108:111], v[120:123], 0
  v_mfma_f32_16x16x32_bf16 v[96:99], v[112:115], v[120:123], 0
  s_nop 7
  v_cvt_pk_bf16_f32 v44, v96, v97
  v_cvt_pk_bf16_f32 v45, v98, v99
  v_lshlrev_b32 v8, 16, v48
  v_sub_f32 v9, v8, v104
  v_sub_f32 v10, v8, v105
  v_cvt_pk_bf16_f32 v11, v9, v10
  v_lshlrev_b32 v9, 16, v11
  v_and_b32 v10, s54, v11
  v_mul_f32 v9, v9, v9
  v_mul_f32 v10, v10, v10
  v_cvt_pk_bf16_f32 v11, v9, v10
  v_lshlrev_b32 v9, 16, v11
  v_and_b32 v10, s54, v11
  v_mul_f32 v9, s55, v9
  v_mul_f32 v10, s55, v10
  v_cvt_pk_bf16_f32 v11, v9, v10
  v_lshlrev_b32 v9, 16, v11
  v_and_b32 v10, s54, v11
  v_mul_f32 v9, s56, v9
  v_mul_f32 v10, s56, v10
  v_exp_f32 v9, v9
  v_exp_f32 v10, v10
  s_nop 0
  v_cvt_pk_bf16_f32 v120, v9, v10
  s_nop 1
  v_mfma_f32_16x16x32_bf16 v[48:51], v[108:111], v[120:123], 0
  v_mfma_f32_16x16x32_bf16 v[96:99], v[112:115], v[120:123], 0
  s_nop 7
  v_cvt_pk_bf16_f32 v52, v96, v97
  v_cvt_pk_bf16_f32 v53, v98, v99
  v_lshlrev_b32 v8, 16, v56
  v_sub_f32 v9, v8, v104
  v_sub_f32 v10, v8, v105
  v_cvt_pk_bf16_f32 v11, v9, v10
  v_lshlrev_b32 v9, 16, v11
  v_and_b32 v10, s54, v11
  v_mul_f32 v9, v9, v9
  v_mul_f32 v10, v10, v10
  v_cvt_pk_bf16_f32 v11, v9, v10
  v_lshlrev_b32 v9, 16, v11
  v_and_b32 v10, s54, v11
  v_mul_f32 v9, s55, v9
  v_mul_f32 v10, s55, v10
  v_cvt_pk_bf16_f32 v11, v9, v10
  v_lshlrev_b32 v9, 16, v11
  v_and_b32 v10, s54, v11
  v_mul_f32 v9, s56, v9
  v_mul_f32 v10, s56, v10
  v_exp_f32 v9, v9
  v_exp_f32 v10, v10
  s_nop 0
  v_cvt_pk_bf16_f32 v120, v9, v10
  s_nop 1
  v_mfma_f32_16x16x32_bf16 v[56:59], v[108:111], v[120:123], 0
  v_mfma_f32_16x16x32_bf16 v[96:99], v[112:115], v[120:123], 0
  s_nop 7
  v_cvt_pk_bf16_f32 v60, v96, v97
  v_cvt_pk_bf16_f32 v61, v98, v99
  v_lshlrev_b32 v8, 16, v64
  v_sub_f32 v9, v8, v104
  v_sub_f32 v10, v8, v105
  v_cvt_pk_bf16_f32 v11, v9, v10
  v_lshlrev_b32 v9, 16, v11
  v_and_b32 v10, s54, v11
  v_mul_f32 v9, v9, v9
  v_mul_f32 v10, v10, v10
  v_cvt_pk_bf16_f32 v11, v9, v10
  v_lshlrev_b32 v9, 16, v11
  v_and_b32 v10, s54, v11
  v_mul_f32 v9, s55, v9
  v_mul_f32 v10, s55, v10
  v_cvt_pk_bf16_f32 v11, v9, v10
  v_lshlrev_b32 v9, 16, v11
  v_and_b32 v10, s54, v11
  v_mul_f32 v9, s56, v9
  v_mul_f32 v10, s56, v10
  v_exp_f32 v9, v9
  v_exp_f32 v10, v10
  s_nop 0
  v_cvt_pk_bf16_f32 v120, v9, v10
  s_nop 1
  v_mfma_f32_16x16x32_bf16 v[64:67], v[108:111], v[120:123], 0
  v_mfma_f32_16x16x32_bf16 v[96:99], v[112:115], v[120:123], 0
  s_nop 7
  v_cvt_pk_bf16_f32 v68, v96, v97
  v_cvt_pk_bf16_f32 v69, v98, v99
  v_lshlrev_b32 v8, 16, v72
  v_sub_f32 v9, v8, v104
  v_sub_f32 v10, v8, v105
  v_cvt_pk_bf16_f32 v11, v9, v10
  v_lshlrev_b32 v9, 16, v11
  v_and_b32 v10, s54, v11
  v_mul_f32 v9, v9, v9
  v_mul_f32 v10, v10, v10
  v_cvt_pk_bf16_f32 v11, v9, v10
  v_lshlrev_b32 v9, 16, v11
  v_and_b32 v10, s54, v11
  v_mul_f32 v9, s55, v9
  v_mul_f32 v10, s55, v10
  v_cvt_pk_bf16_f32 v11, v9, v10
  v_lshlrev_b32 v9, 16, v11
  v_and_b32 v10, s54, v11
  v_mul_f32 v9, s56, v9
  v_mul_f32 v10, s56, v10
  v_exp_f32 v9, v9
  v_exp_f32 v10, v10
  s_nop 0
  v_cvt_pk_bf16_f32 v120, v9, v10
  s_nop 1
  v_mfma_f32_16x16x32_bf16 v[72:75], v[108:111], v[120:123], 0
  v_mfma_f32_16x16x32_bf16 v[96:99], v[112:115], v[120:123], 0
  s_nop 7
  v_cvt_pk_bf16_f32 v76, v96, v97
  v_cvt_pk_bf16_f32 v77, v98, v99
  v_lshlrev_b32 v8, 16, v80
  v_sub_f32 v9, v8, v104
  v_sub_f32 v10, v8, v105
  v_cvt_pk_bf16_f32 v11, v9, v10
  v_lshlrev_b32 v9, 16, v11
  v_and_b32 v10, s54, v11
  v_mul_f32 v9, v9, v9
  v_mul_f32 v10, v10, v10
  v_cvt_pk_bf16_f32 v11, v9, v10
  v_lshlrev_b32 v9, 16, v11
  v_and_b32 v10, s54, v11
  v_mul_f32 v9, s55, v9
  v_mul_f32 v10, s55, v10
  v_cvt_pk_bf16_f32 v11, v9, v10
  v_lshlrev_b32 v9, 16, v11
  v_and_b32 v10, s54, v11
  v_mul_f32 v9, s56, v9
  v_mul_f32 v10, s56, v10
  v_exp_f32 v9, v9
  v_exp_f32 v10, v10
  s_nop 0
  v_cvt_pk_bf16_f32 v120, v9, v10
  s_nop 1
  v_mfma_f32_16x16x32_bf16 v[80:83], v[108:111], v[120:123], 0
  v_mfma_f32_16x16x32_bf16 v[96:99], v[112:115], v[120:123], 0
  s_nop 7
  v_cvt_pk_bf16_f32 v84, v96, v97
  v_cvt_pk_bf16_f32 v85, v98, v99
  v_lshlrev_b32 v8, 16, v88
  v_sub_f32 v9, v8, v104
  v_sub_f32 v10, v8, v105
  v_cvt_pk_bf16_f32 v11, v9, v10
  v_lshlrev_b32 v9, 16, v11
  v_and_b32 v10, s54, v11
  v_mul_f32 v9, v9, v9
  v_mul_f32 v10, v10, v10
  v_cvt_pk_bf16_f32 v11, v9, v10
  v_lshlrev_b32 v9, 16, v11
  v_and_b32 v10, s54, v11
  v_mul_f32 v9, s55, v9
  v_mul_f32 v10, s55, v10
  v_cvt_pk_bf16_f32 v11, v9, v10
  v_lshlrev_b32 v9, 16, v11
  v_and_b32 v10, s54, v11
  v_mul_f32 v9, s56, v9
  v_mul_f32 v10, s56, v10
  v_exp_f32 v9, v9
  v_exp_f32 v10, v10
  s_nop 0
  v_cvt_pk_bf16_f32 v120, v9, v10
  s_nop 1
  v_mfma_f32_16x16x32_bf16 v[88:91], v[108:111], v[120:123], 0
  v_mfma_f32_16x16x32_bf16 v[96:99], v[112:115], v[120:123], 0
  s_nop 7
  v_cvt_pk_bf16_f32 v92, v96, v97
  v_cvt_pk_bf16_f32 v93, v98, v99
  s_load_dwordx2 s[36:37], s[0:1], 72
  s_waitcnt lgkmcnt(0)
  s_mov_b32 s20, s36
  s_mov_b32 s21, s37
  s_mov_b32 s22, 512
  s_mov_b32 s23, 0x20000
  v_lshlrev_b32 v4, 7, v3
  v_lshl_add_u32 v4, v2, 1, v4
  buffer_load_ushort v100, v4, s[20:23], 0 offen offset:0
  buffer_load_ushort v101, v4, s[20:23], 0 offen offset:32
  buffer_load_ushort v102, v4, s[20:23], 0 offen offset:64
  buffer_load_ushort v103, v4, s[20:23], 0 offen offset:96
  s_waitcnt vmcnt(0)
  v_lshl_or_b32 v112, v101, 16, v100
  v_lshl_or_b32 v113, v103, 16, v102
  v_mov_b32 v114, v112
  v_mov_b32 v115, v113
  s_sub_u32 s57, s35, 8
  s_lshl_b32 s58, s57, 2
  v_mov_b32 v4, 138240
  v_add_u32 v4, s58, v4
  s_mov_b32 s59, 1
L_ep_poll:
  ds_read_b32 v6, v4 offset:32
  s_waitcnt lgkmcnt(0)
  v_readfirstlane_b32 s58, v6
  s_nop 3
  s_cmp_ge_u32 s58, s59
  s_cbranch_scc1 L_ep_poll_ok
  s_sleep 4
  s_branch L_ep_poll
L_ep_poll_ok:
  s_mul_i32 s57, s57, 5280
  s_add_u32 s57, s57, 42240
  v_lshlrev_b32 v4, 4, v1
  v_add_u32 v4, s57, v4
  v_mov_b32 v124, 0x7fffff00
  s_movk_i32 s57, 1250
  ds_read_b128 v[96:99], v4 offset:0
  ds_read_b128 v[100:103], v4 offset:1024
  s_waitcnt lgkmcnt(1)
  v_cvt_pk_bf16_f32 v104, v96, v97
  v_cvt_pk_bf16_f32 v105, v98, v99
  v_lshlrev_b32 v12, 16, v104
  v_and_b32 v13, s54, v104
  v_lshlrev_b32 v14, 16, v105
  v_and_b32 v125, s54, v105
  v_sub_f32 v8, v96, v12
  v_sub_f32 v9, v97, v13
  v_sub_f32 v10, v98, v14
  v_sub_f32 v11, v99, v125
  v_cvt_pk_bf16_f32 v106, v8, v9
  v_cvt_pk_bf16_f32 v107, v10, v11
  s_nop 1
  v_mfma_f32_16x16x32_bf16 v[120:123], v[112:115], v[104:107], 0
  s_nop 7
  v_mul_f32 v8, v120, v16
  v_mul_f32 v9, v121, v17
  v_mul_f32 v10, v122, v18
  v_mul_f32 v11, v123, v19
  v_cvt_pk_bf16_f32 v104, v8, v9
  v_cvt_pk_bf16_f32 v105, v10, v11
  v_lshlrev_b32 v12, 16, v104
  v_and_b32 v13, s54, v104
  v_lshlrev_b32 v14, 16, v105
  v_and_b32 v125, s54, v105
  v_sub_f32 v8, v8, v12
  v_sub_f32 v9, v9, v13
  v_sub_f32 v10, v10, v14
  v_sub_f32 v11, v11, v125
  v_cvt_pk_bf16_f32 v106, v8, v9
  v_cvt_pk_bf16_f32 v107, v10, v11
  v_add_u32 v6, 0, v5
  v_cmp_gt_u32 vcc, s57, v6
  v_mfma_f32_16x16x32_bf16 v[108:111], v[116:119], v[104:107], 0
  v_add_u32 v6, s53, v6
  v_lshlrev_b32 v6, 5, v6
  v_lshl_add_u32 v6, v3, 3, v6
  v_cndmask_b32 v6, v124, v6, vcc
  v_lshlrev_b32 v8, 16, v20
  v_and_b32 v9, s54, v20
  v_lshlrev_b32 v10, 16, v21
  v_and_b32 v11, s54, v21
  v_lshlrev_b32 v12, 16, v22
  v_and_b32 v13, s54, v22
  v_lshlrev_b32 v14, 16, v23
  v_and_b32 v125, s54, v23
  v_fma_f32 v12, v108, v8, v12
  v_fma_f32 v13, v109, v9, v13
  v_fma_f32 v14, v110, v10, v14
  v_fma_f32 v125, v111, v11, v125
  v_cvt_pk_bf16_f32 v20, v12, v13
  v_cvt_pk_bf16_f32 v21, v14, v125
  buffer_store_dwordx2 v[20:21], v6, s[16:19], 0 offen
  ds_read_b128 v[96:99], v4 offset:2048
  s_waitcnt lgkmcnt(1)
  v_cvt_pk_bf16_f32 v104, v100, v101
  v_cvt_pk_bf16_f32 v105, v102, v103
  v_lshlrev_b32 v12, 16, v104
  v_and_b32 v13, s54, v104
  v_lshlrev_b32 v14, 16, v105
  v_and_b32 v125, s54, v105
  v_sub_f32 v8, v100, v12
  v_sub_f32 v9, v101, v13
  v_sub_f32 v10, v102, v14
  v_sub_f32 v11, v103, v125
  v_cvt_pk_bf16_f32 v106, v8, v9
  v_cvt_pk_bf16_f32 v107, v10, v11
  s_nop 1
  v_mfma_f32_16x16x32_bf16 v[120:123], v[112:115], v[104:107], 0
  s_nop 7
  v_mul_f32 v8, v120, v24
  v_mul_f32 v9, v121, v25
  v_mul_f32 v10, v122, v26
  v_mul_f32 v11, v123, v27
  v_cvt_pk_bf16_f32 v104, v8, v9
  v_cvt_pk_bf16_f32 v105, v10, v11
  v_lshlrev_b32 v12, 16, v104
  v_and_b32 v13, s54, v104
  v_lshlrev_b32 v14, 16, v105
  v_and_b32 v125, s54, v105
  v_sub_f32 v8, v8, v12
  v_sub_f32 v9, v9, v13
  v_sub_f32 v10, v10, v14
  v_sub_f32 v11, v11, v125
  v_cvt_pk_bf16_f32 v106, v8, v9
  v_cvt_pk_bf16_f32 v107, v10, v11
  v_add_u32 v6, 16, v5
  v_cmp_gt_u32 vcc, s57, v6
  v_mfma_f32_16x16x32_bf16 v[108:111], v[116:119], v[104:107], 0
  v_add_u32 v6, s53, v6
  v_lshlrev_b32 v6, 5, v6
  v_lshl_add_u32 v6, v3, 3, v6
  v_cndmask_b32 v6, v124, v6, vcc
  v_lshlrev_b32 v8, 16, v28
  v_and_b32 v9, s54, v28
  v_lshlrev_b32 v10, 16, v29
  v_and_b32 v11, s54, v29
  v_lshlrev_b32 v12, 16, v30
  v_and_b32 v13, s54, v30
  v_lshlrev_b32 v14, 16, v31
  v_and_b32 v125, s54, v31
  v_fma_f32 v12, v108, v8, v12
  v_fma_f32 v13, v109, v9, v13
  v_fma_f32 v14, v110, v10, v14
  v_fma_f32 v125, v111, v11, v125
  v_cvt_pk_bf16_f32 v28, v12, v13
  v_cvt_pk_bf16_f32 v29, v14, v125
  buffer_store_dwordx2 v[28:29], v6, s[16:19], 0 offen
  ds_read_b128 v[100:103], v4 offset:3072
  s_waitcnt lgkmcnt(1)
  v_cvt_pk_bf16_f32 v104, v96, v97
  v_cvt_pk_bf16_f32 v105, v98, v99
  v_lshlrev_b32 v12, 16, v104
  v_and_b32 v13, s54, v104
  v_lshlrev_b32 v14, 16, v105
  v_and_b32 v125, s54, v105
  v_sub_f32 v8, v96, v12
  v_sub_f32 v9, v97, v13
  v_sub_f32 v10, v98, v14
  v_sub_f32 v11, v99, v125
  v_cvt_pk_bf16_f32 v106, v8, v9
  v_cvt_pk_bf16_f32 v107, v10, v11
  s_nop 1
  v_mfma_f32_16x16x32_bf16 v[120:123], v[112:115], v[104:107], 0
  s_nop 7
  v_mul_f32 v8, v120, v32
  v_mul_f32 v9, v121, v33
  v_mul_f32 v10, v122, v34
  v_mul_f32 v11, v123, v35
  v_cvt_pk_bf16_f32 v104, v8, v9
  v_cvt_pk_bf16_f32 v105, v10, v11
  v_lshlrev_b32 v12, 16, v104
  v_and_b32 v13, s54, v104
  v_lshlrev_b32 v14, 16, v105
  v_and_b32 v125, s54, v105
  v_sub_f32 v8, v8, v12
  v_sub_f32 v9, v9, v13
  v_sub_f32 v10, v10, v14
  v_sub_f32 v11, v11, v125
  v_cvt_pk_bf16_f32 v106, v8, v9
  v_cvt_pk_bf16_f32 v107, v10, v11
  v_add_u32 v6, 32, v5
  v_cmp_gt_u32 vcc, s57, v6
  v_mfma_f32_16x16x32_bf16 v[108:111], v[116:119], v[104:107], 0
  v_add_u32 v6, s53, v6
  v_lshlrev_b32 v6, 5, v6
  v_lshl_add_u32 v6, v3, 3, v6
  v_cndmask_b32 v6, v124, v6, vcc
  v_lshlrev_b32 v8, 16, v36
  v_and_b32 v9, s54, v36
  v_lshlrev_b32 v10, 16, v37
  v_and_b32 v11, s54, v37
  v_lshlrev_b32 v12, 16, v38
  v_and_b32 v13, s54, v38
  v_lshlrev_b32 v14, 16, v39
  v_and_b32 v125, s54, v39
  v_fma_f32 v12, v108, v8, v12
  v_fma_f32 v13, v109, v9, v13
  v_fma_f32 v14, v110, v10, v14
  v_fma_f32 v125, v111, v11, v125
  v_cvt_pk_bf16_f32 v36, v12, v13
  v_cvt_pk_bf16_f32 v37, v14, v125
  buffer_store_dwordx2 v[36:37], v6, s[16:19], 0 offen
  ds_read_b128 v[96:99], v4 offset:4096
  s_waitcnt lgkmcnt(1)
  v_cvt_pk_bf16_f32 v104, v100, v101
  v_cvt_pk_bf16_f32 v105, v102, v103
  v_lshlrev_b32 v12, 16, v104
  v_and_b32 v13, s54, v104
  v_lshlrev_b32 v14, 16, v105
  v_and_b32 v125, s54, v105
  v_sub_f32 v8, v100, v12
  v_sub_f32 v9, v101, v13
  v_sub_f32 v10, v102, v14
  v_sub_f32 v11, v103, v125
  v_cvt_pk_bf16_f32 v106, v8, v9
  v_cvt_pk_bf16_f32 v107, v10, v11
  s_nop 1
  v_mfma_f32_16x16x32_bf16 v[120:123], v[112:115], v[104:107], 0
  s_nop 7
  v_mul_f32 v8, v120, v40
  v_mul_f32 v9, v121, v41
  v_mul_f32 v10, v122, v42
  v_mul_f32 v11, v123, v43
  v_cvt_pk_bf16_f32 v104, v8, v9
  v_cvt_pk_bf16_f32 v105, v10, v11
  v_lshlrev_b32 v12, 16, v104
  v_and_b32 v13, s54, v104
  v_lshlrev_b32 v14, 16, v105
  v_and_b32 v125, s54, v105
  v_sub_f32 v8, v8, v12
  v_sub_f32 v9, v9, v13
  v_sub_f32 v10, v10, v14
  v_sub_f32 v11, v11, v125
  v_cvt_pk_bf16_f32 v106, v8, v9
  v_cvt_pk_bf16_f32 v107, v10, v11
  v_add_u32 v6, 48, v5
  v_cmp_gt_u32 vcc, s57, v6
  v_mfma_f32_16x16x32_bf16 v[108:111], v[116:119], v[104:107], 0
  v_add_u32 v6, s53, v6
  v_lshlrev_b32 v6, 5, v6
  v_lshl_add_u32 v6, v3, 3, v6
  v_cndmask_b32 v6, v124, v6, vcc
  v_lshlrev_b32 v8, 16, v44
  v_and_b32 v9, s54, v44
  v_lshlrev_b32 v10, 16, v45
  v_and_b32 v11, s54, v45
  v_lshlrev_b32 v12, 16, v46
  v_and_b32 v13, s54, v46
  v_lshlrev_b32 v14, 16, v47
  v_and_b32 v125, s54, v47
  v_fma_f32 v12, v108, v8, v12
  v_fma_f32 v13, v109, v9, v13
  v_fma_f32 v14, v110, v10, v14
  v_fma_f32 v125, v111, v11, v125
  v_cvt_pk_bf16_f32 v44, v12, v13
  v_cvt_pk_bf16_f32 v45, v14, v125
  buffer_store_dwordx2 v[44:45], v6, s[16:19], 0 offen
  ds_read_b128 v[100:103], v4 offset:42240
  s_waitcnt lgkmcnt(1)
  v_cvt_pk_bf16_f32 v104, v96, v97
  v_cvt_pk_bf16_f32 v105, v98, v99
  v_lshlrev_b32 v12, 16, v104
  v_and_b32 v13, s54, v104
  v_lshlrev_b32 v14, 16, v105
  v_and_b32 v125, s54, v105
  v_sub_f32 v8, v96, v12
  v_sub_f32 v9, v97, v13
  v_sub_f32 v10, v98, v14
  v_sub_f32 v11, v99, v125
  v_cvt_pk_bf16_f32 v106, v8, v9
  v_cvt_pk_bf16_f32 v107, v10, v11
  s_nop 1
  v_mfma_f32_16x16x32_bf16 v[120:123], v[112:115], v[104:107], 0
  s_nop 7
  v_mul_f32 v8, v120, v48
  v_mul_f32 v9, v121, v49
  v_mul_f32 v10, v122, v50
  v_mul_f32 v11, v123, v51
  v_cvt_pk_bf16_f32 v104, v8, v9
  v_cvt_pk_bf16_f32 v105, v10, v11
  v_lshlrev_b32 v12, 16, v104
  v_and_b32 v13, s54, v104
  v_lshlrev_b32 v14, 16, v105
  v_and_b32 v125, s54, v105
  v_sub_f32 v8, v8, v12
  v_sub_f32 v9, v9, v13
  v_sub_f32 v10, v10, v14
  v_sub_f32 v11, v11, v125
  v_cvt_pk_bf16_f32 v106, v8, v9
  v_cvt_pk_bf16_f32 v107, v10, v11
  v_add_u32 v6, 64, v5
  v_cmp_gt_u32 vcc, s57, v6
  v_mfma_f32_16x16x32_bf16 v[108:111], v[116:119], v[104:107], 0
  v_add_u32 v6, s53, v6
  v_lshlrev_b32 v6, 5, v6
  v_lshl_add_u32 v6, v3, 3, v6
  v_cndmask_b32 v6, v124, v6, vcc
  v_lshlrev_b32 v8, 16, v52
  v_and_b32 v9, s54, v52
  v_lshlrev_b32 v10, 16, v53
  v_and_b32 v11, s54, v53
  v_lshlrev_b32 v12, 16, v54
  v_and_b32 v13, s54, v54
  v_lshlrev_b32 v14, 16, v55
  v_and_b32 v125, s54, v55
  v_fma_f32 v12, v108, v8, v12
  v_fma_f32 v13, v109, v9, v13
  v_fma_f32 v14, v110, v10, v14
  v_fma_f32 v125, v111, v11, v125
  v_cvt_pk_bf16_f32 v52, v12, v13
  v_cvt_pk_bf16_f32 v53, v14, v125
  buffer_store_dwordx2 v[52:53], v6, s[16:19], 0 offen
  ds_read_b128 v[96:99], v4 offset:43264
  s_waitcnt lgkmcnt(1)
  v_cvt_pk_bf16_f32 v104, v100, v101
  v_cvt_pk_bf16_f32 v105, v102, v103
  v_lshlrev_b32 v12, 16, v104
  v_and_b32 v13, s54, v104
  v_lshlrev_b32 v14, 16, v105
  v_and_b32 v125, s54, v105
  v_sub_f32 v8, v100, v12
  v_sub_f32 v9, v101, v13
  v_sub_f32 v10, v102, v14
  v_sub_f32 v11, v103, v125
  v_cvt_pk_bf16_f32 v106, v8, v9
  v_cvt_pk_bf16_f32 v107, v10, v11
  s_nop 1
  v_mfma_f32_16x16x32_bf16 v[120:123], v[112:115], v[104:107], 0
  s_nop 7
  v_mul_f32 v8, v120, v56
  v_mul_f32 v9, v121, v57
  v_mul_f32 v10, v122, v58
  v_mul_f32 v11, v123, v59
  v_cvt_pk_bf16_f32 v104, v8, v9
  v_cvt_pk_bf16_f32 v105, v10, v11
  v_lshlrev_b32 v12, 16, v104
  v_and_b32 v13, s54, v104
  v_lshlrev_b32 v14, 16, v105
  v_and_b32 v125, s54, v105
  v_sub_f32 v8, v8, v12
  v_sub_f32 v9, v9, v13
  v_sub_f32 v10, v10, v14
  v_sub_f32 v11, v11, v125
  v_cvt_pk_bf16_f32 v106, v8, v9
  v_cvt_pk_bf16_f32 v107, v10, v11
  v_add_u32 v6, 80, v5
  v_cmp_gt_u32 vcc, s57, v6
  v_mfma_f32_16x16x32_bf16 v[108:111], v[116:119], v[104:107], 0
  v_add_u32 v6, s53, v6
  v_lshlrev_b32 v6, 5, v6
  v_lshl_add_u32 v6, v3, 3, v6
  v_cndmask_b32 v6, v124, v6, vcc
  v_lshlrev_b32 v8, 16, v60
  v_and_b32 v9, s54, v60
  v_lshlrev_b32 v10, 16, v61
  v_and_b32 v11, s54, v61
  v_lshlrev_b32 v12, 16, v62
  v_and_b32 v13, s54, v62
  v_lshlrev_b32 v14, 16, v63
  v_and_b32 v125, s54, v63
  v_fma_f32 v12, v108, v8, v12
  v_fma_f32 v13, v109, v9, v13
  v_fma_f32 v14, v110, v10, v14
  v_fma_f32 v125, v111, v11, v125
  v_cvt_pk_bf16_f32 v60, v12, v13
  v_cvt_pk_bf16_f32 v61, v14, v125
  buffer_store_dwordx2 v[60:61], v6, s[16:19], 0 offen
  ds_read_b128 v[100:103], v4 offset:44288
  s_waitcnt lgkmcnt(1)
  v_cvt_pk_bf16_f32 v104, v96, v97
  v_cvt_pk_bf16_f32 v105, v98, v99
  v_lshlrev_b32 v12, 16, v104
  v_and_b32 v13, s54, v104
  v_lshlrev_b32 v14, 16, v105
  v_and_b32 v125, s54, v105
  v_sub_f32 v8, v96, v12
  v_sub_f32 v9, v97, v13
  v_sub_f32 v10, v98, v14
  v_sub_f32 v11, v99, v125
  v_cvt_pk_bf16_f32 v106, v8, v9
  v_cvt_pk_bf16_f32 v107, v10, v11
  s_nop 1
  v_mfma_f32_16x16x32_bf16 v[120:123], v[112:115], v[104:107], 0
  s_nop 7
  v_mul_f32 v8, v120, v64
  v_mul_f32 v9, v121, v65
  v_mul_f32 v10, v122, v66
  v_mul_f32 v11, v123, v67
  v_cvt_pk_bf16_f32 v104, v8, v9
  v_cvt_pk_bf16_f32 v105, v10, v11
  v_lshlrev_b32 v12, 16, v104
  v_and_b32 v13, s54, v104
  v_lshlrev_b32 v14, 16, v105
  v_and_b32 v125, s54, v105
  v_sub_f32 v8, v8, v12
  v_sub_f32 v9, v9, v13
  v_sub_f32 v10, v10, v14
  v_sub_f32 v11, v11, v125
  v_cvt_pk_bf16_f32 v106, v8, v9
  v_cvt_pk_bf16_f32 v107, v10, v11
  v_add_u32 v6, 96, v5
  v_cmp_gt_u32 vcc, s57, v6
  v_mfma_f32_16x16x32_bf16 v[108:111], v[116:119], v[104:107], 0
  v_add_u32 v6, s53, v6
  v_lshlrev_b32 v6, 5, v6
  v_lshl_add_u32 v6, v3, 3, v6
  v_cndmask_b32 v6, v124, v6, vcc
  v_lshlrev_b32 v8, 16, v68
  v_and_b32 v9, s54, v68
  v_lshlrev_b32 v10, 16, v69
  v_and_b32 v11, s54, v69
  v_lshlrev_b32 v12, 16, v70
  v_and_b32 v13, s54, v70
  v_lshlrev_b32 v14, 16, v71
  v_and_b32 v125, s54, v71
  v_fma_f32 v12, v108, v8, v12
  v_fma_f32 v13, v109, v9, v13
  v_fma_f32 v14, v110, v10, v14
  v_fma_f32 v125, v111, v11, v125
  v_cvt_pk_bf16_f32 v68, v12, v13
  v_cvt_pk_bf16_f32 v69, v14, v125
  buffer_store_dwordx2 v[68:69], v6, s[16:19], 0 offen
  ds_read_b128 v[96:99], v4 offset:45312
  s_waitcnt lgkmcnt(1)
  v_cvt_pk_bf16_f32 v104, v100, v101
  v_cvt_pk_bf16_f32 v105, v102, v103
  v_lshlrev_b32 v12, 16, v104
  v_and_b32 v13, s54, v104
  v_lshlrev_b32 v14, 16, v105
  v_and_b32 v125, s54, v105
  v_sub_f32 v8, v100, v12
  v_sub_f32 v9, v101, v13
  v_sub_f32 v10, v102, v14
  v_sub_f32 v11, v103, v125
  v_cvt_pk_bf16_f32 v106, v8, v9
  v_cvt_pk_bf16_f32 v107, v10, v11
  s_nop 1
  v_mfma_f32_16x16x32_bf16 v[120:123], v[112:115], v[104:107], 0
  s_nop 7
  v_mul_f32 v8, v120, v72
  v_mul_f32 v9, v121, v73
  v_mul_f32 v10, v122, v74
  v_mul_f32 v11, v123, v75
  v_cvt_pk_bf16_f32 v104, v8, v9
  v_cvt_pk_bf16_f32 v105, v10, v11
  v_lshlrev_b32 v12, 16, v104
  v_and_b32 v13, s54, v104
  v_lshlrev_b32 v14, 16, v105
  v_and_b32 v125, s54, v105
  v_sub_f32 v8, v8, v12
  v_sub_f32 v9, v9, v13
  v_sub_f32 v10, v10, v14
  v_sub_f32 v11, v11, v125
  v_cvt_pk_bf16_f32 v106, v8, v9
  v_cvt_pk_bf16_f32 v107, v10, v11
  v_add_u32 v6, 112, v5
  v_cmp_gt_u32 vcc, s57, v6
  v_mfma_f32_16x16x32_bf16 v[108:111], v[116:119], v[104:107], 0
  v_add_u32 v6, s53, v6
  v_lshlrev_b32 v6, 5, v6
  v_lshl_add_u32 v6, v3, 3, v6
  v_cndmask_b32 v6, v124, v6, vcc
  v_lshlrev_b32 v8, 16, v76
  v_and_b32 v9, s54, v76
  v_lshlrev_b32 v10, 16, v77
  v_and_b32 v11, s54, v77
  v_lshlrev_b32 v12, 16, v78
  v_and_b32 v13, s54, v78
  v_lshlrev_b32 v14, 16, v79
  v_and_b32 v125, s54, v79
  v_fma_f32 v12, v108, v8, v12
  v_fma_f32 v13, v109, v9, v13
  v_fma_f32 v14, v110, v10, v14
  v_fma_f32 v125, v111, v11, v125
  v_cvt_pk_bf16_f32 v76, v12, v13
  v_cvt_pk_bf16_f32 v77, v14, v125
  buffer_store_dwordx2 v[76:77], v6, s[16:19], 0 offen
  ds_read_b128 v[100:103], v4 offset:46336
  s_waitcnt lgkmcnt(1)
  v_cvt_pk_bf16_f32 v104, v96, v97
  v_cvt_pk_bf16_f32 v105, v98, v99
  v_lshlrev_b32 v12, 16, v104
  v_and_b32 v13, s54, v104
  v_lshlrev_b32 v14, 16, v105
  v_and_b32 v125, s54, v105
  v_sub_f32 v8, v96, v12
  v_sub_f32 v9, v97, v13
  v_sub_f32 v10, v98, v14
  v_sub_f32 v11, v99, v125
  v_cvt_pk_bf16_f32 v106, v8, v9
  v_cvt_pk_bf16_f32 v107, v10, v11
  s_nop 1
  v_mfma_f32_16x16x32_bf16 v[120:123], v[112:115], v[104:107], 0
  s_nop 7
  v_mul_f32 v8, v120, v80
  v_mul_f32 v9, v121, v81
  v_mul_f32 v10, v122, v82
  v_mul_f32 v11, v123, v83
  v_cvt_pk_bf16_f32 v104, v8, v9
  v_cvt_pk_bf16_f32 v105, v10, v11
  v_lshlrev_b32 v12, 16, v104
  v_and_b32 v13, s54, v104
  v_lshlrev_b32 v14, 16, v105
  v_and_b32 v125, s54, v105
  v_sub_f32 v8, v8, v12
  v_sub_f32 v9, v9, v13
  v_sub_f32 v10, v10, v14
  v_sub_f32 v11, v11, v125
  v_cvt_pk_bf16_f32 v106, v8, v9
  v_cvt_pk_bf16_f32 v107, v10, v11
  v_add_u32 v6, 128, v5
  v_cmp_gt_u32 vcc, s57, v6
  v_mfma_f32_16x16x32_bf16 v[108:111], v[116:119], v[104:107], 0
  v_add_u32 v6, s53, v6
  v_lshlrev_b32 v6, 5, v6
  v_lshl_add_u32 v6, v3, 3, v6
  v_cndmask_b32 v6, v124, v6, vcc
  v_lshlrev_b32 v8, 16, v84
  v_and_b32 v9, s54, v84
  v_lshlrev_b32 v10, 16, v85
  v_and_b32 v11, s54, v85
  v_lshlrev_b32 v12, 16, v86
  v_and_b32 v13, s54, v86
  v_lshlrev_b32 v14, 16, v87
  v_and_b32 v125, s54, v87
  v_fma_f32 v12, v108, v8, v12
  v_fma_f32 v13, v109, v9, v13
  v_fma_f32 v14, v110, v10, v14
  v_fma_f32 v125, v111, v11, v125
  v_cvt_pk_bf16_f32 v84, v12, v13
  v_cvt_pk_bf16_f32 v85, v14, v125
  buffer_store_dwordx2 v[84:85], v6, s[16:19], 0 offen
  s_waitcnt lgkmcnt(0)
  v_cvt_pk_bf16_f32 v104, v100, v101
  v_cvt_pk_bf16_f32 v105, v102, v103
  v_lshlrev_b32 v12, 16, v104
  v_and_b32 v13, s54, v104
  v_lshlrev_b32 v14, 16, v105
  v_and_b32 v125, s54, v105
  v_sub_f32 v8, v100, v12
  v_sub_f32 v9, v101, v13
  v_sub_f32 v10, v102, v14
  v_sub_f32 v11, v103, v125
  v_cvt_pk_bf16_f32 v106, v8, v9
  v_cvt_pk_bf16_f32 v107, v10, v11
  s_nop 1
  v_mfma_f32_16x16x32_bf16 v[120:123], v[112:115], v[104:107], 0
  s_nop 7
  v_mul_f32 v8, v120, v88
  v_mul_f32 v9, v121, v89
  v_mul_f32 v10, v122, v90
  v_mul_f32 v11, v123, v91
  v_cvt_pk_bf16_f32 v104, v8, v9
  v_cvt_pk_bf16_f32 v105, v10, v11
  v_lshlrev_b32 v12, 16, v104
  v_and_b32 v13, s54, v104
  v_lshlrev_b32 v14, 16, v105
  v_and_b32 v125, s54, v105
  v_sub_f32 v8, v8, v12
  v_sub_f32 v9, v9, v13
  v_sub_f32 v10, v10, v14
  v_sub_f32 v11, v11, v125
  v_cvt_pk_bf16_f32 v106, v8, v9
  v_cvt_pk_bf16_f32 v107, v10, v11
  v_add_u32 v6, 144, v5
  v_cmp_gt_u32 vcc, s57, v6
  v_mfma_f32_16x16x32_bf16 v[108:111], v[116:119], v[104:107], 0
  v_add_u32 v6, s53, v6
  v_lshlrev_b32 v6, 5, v6
  v_lshl_add_u32 v6, v3, 3, v6
  v_cndmask_b32 v6, v124, v6, vcc
  v_lshlrev_b32 v8, 16, v92
  v_and_b32 v9, s54, v92
  v_lshlrev_b32 v10, 16, v93
  v_and_b32 v11, s54, v93
  v_lshlrev_b32 v12, 16, v94
  v_and_b32 v13, s54, v94
  v_lshlrev_b32 v14, 16, v95
  v_and_b32 v125, s54, v95
  v_fma_f32 v12, v108, v8, v12
  v_fma_f32 v13, v109, v9, v13
  v_fma_f32 v14, v110, v10, v14
  v_fma_f32 v125, v111, v11, v125
  v_cvt_pk_bf16_f32 v92, v12, v13
  v_cvt_pk_bf16_f32 v93, v14, v125
  buffer_store_dwordx2 v[92:93], v6, s[16:19], 0 offen
  s_endpgm
.section .rodata,"a"
.p2align 6
.amdhsa_kernel k1_kernel
  .amdhsa_next_free_vgpr 128
  .amdhsa_next_free_sgpr 96
  .amdhsa_accum_offset 128
  .amdhsa_group_segment_fixed_size 0
  .amdhsa_kernarg_size 112
  .amdhsa_user_sgpr_count 2
  .amdhsa_user_sgpr_kernarg_segment_ptr 1
  .amdhsa_system_sgpr_workgroup_id_x 1
  .amdhsa_float_denorm_mode_32 3
.end_amdhsa_kernel
.p2align 6
.amdhsa_kernel k2_kernel
  .amdhsa_next_free_vgpr 128
  .amdhsa_next_free_sgpr 100
  .amdhsa_accum_offset 128
  .amdhsa_group_segment_fixed_size 0
  .amdhsa_kernarg_size 112
  .amdhsa_user_sgpr_count 2
  .amdhsa_user_sgpr_kernarg_segment_ptr 1
  .amdhsa_system_sgpr_workgroup_id_x 1
  .amdhsa_float_denorm_mode_32 3
.end_amdhsa_kernel
```
